```python
import torch

def _softmax(x, axis=-1):
    return torch.softmax(x, dim=axis)
def _gelu(x):
    return torch.nn.functional.gelu(x, approximate="tanh")
def _silu(x):
    return torch.nn.functional.silu(x)
def _sigmoid(x):
    return torch.sigmoid(x)
def _layernorm(x, axis=-1, eps=1e-5):
    m = x.mean(dim=axis, keepdim=True)
    v = x.var(dim=axis, keepdim=True, unbiased=False)
    return (x - m) / torch.sqrt(v + eps)
def _scatter_add(tgt, idx, src, axis=0):
    return tgt.clone().index_add_(axis, idx, src)
def _segment_sum(src, seg, n):
    out = torch.zeros((n,) + src.shape[1:], dtype=src.dtype)
    return out.index_add_(0, seg, src)
def _pad(x, pw):
    flat = tuple(v for pair in reversed(pw) for v in pair)
    return torch.nn.functional.pad(x, flat)

kernel_name = 'standalone__gqa_softmax__near_ridge'

def setup_inputs():

    _w = (lambda a: (lambda t: t.to(torch.bfloat16) if t.is_floating_point() else t)(torch.as_tensor(a)))
    B, Hq, Hkv, Sq, Sk, D = 16, 16, 8, 384, 512, 256
    return {
        "q": _w((lambda *s: torch.randn(*s, dtype=torch.bfloat16) * 0.8)(B, Hq, Sq, D)),
        "k": _w((lambda *s: torch.randn(*s, dtype=torch.bfloat16) * 0.8)(B, Hkv, Sk, D)),
        "v": _w((lambda *s: torch.randn(*s, dtype=torch.bfloat16) * 0.05)(B, Hkv, Sk, D)),
    }

def reference(q, k, v):
    B, Hq, Sq, D = q.shape
    Hkv = k.shape[1]
    rep = Hq // Hkv
    k = (lambda x, n, axis: torch.repeat_interleave(x, n, dim=axis))(k, rep, axis=1)
    v = (lambda x, n, axis: torch.repeat_interleave(x, n, dim=axis))(v, rep, axis=1)
    scale = D ** -0.5
    scores = torch.einsum("bhqd,bhkd->bhqk", q, k) * scale
    p = _softmax(scores, axis=-1)
    return torch.einsum("bhqk,bhkd->bhqd", p, v)
```

```asm
; @launch grid=(256,1,1) block=(256,1,1) lds=163840
.amdgcn_target "amdgcn-amd-amdhsa--gfx950"
.text
.globl standalone__gqa_softmax__near_ridge_kernel
.p2align 8
.type standalone__gqa_softmax__near_ridge_kernel,@function
standalone__gqa_softmax__near_ridge_kernel:
    s_cmp_ge_u32 s2, 256
    s_cbranch_scc1 L_end
    s_load_dwordx4 s[48:51], s[0:1], 0
    s_load_dwordx4 s[52:55], s[0:1], 16
    s_bfe_u32 s3, s2, 0x40003
    v_lshrrev_b32 v2, 6, v0
    v_lshl_add_u32 v2, s3, 2, v2
    s_getpc_b64 s[60:61]
L_pc:
    v_and_b32 v1, 7, v0
    v_lshl_add_u32 v1, v2, 3, v1
    v_lshlrev_b32 v1, 7, v1
    v_min_u32 v1, L_end-L_pc, v1
    global_load_dword v44, v1, s[60:61]
    v_and_b32 v1, 3, v0
    v_lshl_add_u32 v25, v2, 2, v1
    v_lshlrev_b32 v25, 7, v25
    v_min_u32 v25, L_end-L_tail, v25
    v_lshrrev_b32 v34, 6, v0
    v_and_b32 v0, 63, v0
    s_nop 0
    v_readfirstlane_b32 s24, v34
    v_lshrrev_b32 v34, 3, v0
    v_and_b32 v35, 6, v34
    v_and_b32 v36, 7, v0
    v_xor_b32 v35, v35, v36
    v_lshlrev_b32 v35, 4, v35
    v_lshl_add_u32 v7, v34, 9, v35
    s_and_b32 s3, s2, 7
    s_lshr_b32 s35, s2, 3
    s_lshl_b32 s3, s3, 3
    s_lshr_b32 s39, s35, 2
    s_add_u32 s3, s3, s39
    s_and_b32 s39, s35, 3
    s_lshl_b32 s45, s3, 18
    s_mul_i32 s33, s3, 5
    s_and_b32 s33, s33, 15
    s_lshl_b32 s33, s33, 14
    s_lshl_b32 s40, s24, 12
    s_add_u32 s33, s33, s40
    s_mul_i32 s3, s3, 768
    s_mul_i32 s35, s39, 192
    s_add_u32 s3, s3, s35
    s_mul_i32 s35, s24, 48
    s_add_u32 s3, s3, s35
    s_lshl_b32 s31, s3, 9
    s_lshl_b32 s38, s24, 13
    s_add_u32 s38, s38, 131072
    s_add_u32 s64, s40, 0
    s_add_u32 s65, s40, 896
    s_add_u32 s66, s40, 1792
    s_add_u32 s67, s40, 2688
    s_add_u32 s68, s40, 16384
    s_add_u32 s69, s40, 17280
    s_add_u32 s70, s40, 18176
    s_add_u32 s71, s40, 19072
    s_add_u32 s72, s40, 32768
    s_add_u32 s73, s40, 33664
    s_add_u32 s74, s40, 34560
    s_add_u32 s75, s40, 35456
    s_add_u32 s76, s40, 49152
    s_add_u32 s77, s40, 50048
    s_add_u32 s78, s40, 50944
    s_add_u32 s79, s40, 51840
    s_add_u32 s80, s40, 65536
    s_add_u32 s81, s40, 66432
    s_add_u32 s82, s40, 67328
    s_add_u32 s83, s40, 68224
    s_add_u32 s84, s40, 81920
    s_add_u32 s85, s40, 82816
    s_add_u32 s86, s40, 83712
    s_add_u32 s87, s40, 84608
    s_add_u32 s88, s40, 98304
    s_add_u32 s89, s40, 99200
    s_add_u32 s90, s40, 100096
    s_add_u32 s91, s40, 100992
    s_add_u32 s92, s40, 114688
    s_add_u32 s93, s40, 115584
    s_add_u32 s94, s40, 116480
    s_add_u32 s95, s40, 117376
    s_mov_b32 s28, 0
    s_mov_b64 s[42:43], 0
    s_mov_b32 s44, 0
    s_mov_b32 s29, 0x3db8aa3b
    s_mov_b32 s30, 0xbdb8aa3b
    s_mov_b32 s36, 0x53800000
    s_mov_b32 s7, 0x20000
    s_mov_b32 s11, 0x20000
    s_mov_b32 s15, 0x20000
    s_mov_b32 s19, 0x20000
    s_mov_b32 s23, 0x20000
    s_mov_b32 s6, 50331648
    s_mov_b32 s22, 0
    s_mov_b32 s18, 50331648
    s_waitcnt lgkmcnt(0)
    s_add_u32 s0, s60, L_tail-L_pc
    s_addc_u32 s1, s61, 0
    s_add_u32 s50, s50, s45
    s_addc_u32 s51, s51, 0
    s_add_u32 s52, s52, s45
    s_addc_u32 s53, s53, 0
    s_mov_b32 s4, s48
    s_mov_b32 s5, s49
    s_mov_b32 s16, s54
    s_mov_b32 s17, s55
    s_mov_b32 s20, s48
    s_mov_b32 s21, s49
    s_lshl_b32 s2, s39, 2
    s_add_u32 s2, s2, s24
L_load:
    s_mov_b32 s25, s33
    s_mov_b32 s26, s33
    s_mov_b32 s8, s50
    s_mov_b32 s9, s51
    s_mov_b32 s10, 262144
    s_mov_b32 s12, s52
    s_mov_b32 s13, s53
    s_mov_b32 s14, 262144
    s_mov_b32 m0, s64
    s_nop 0
    buffer_load_dwordx4 v7, s[8:11], s25 offen lds
    s_mov_b32 m0, s65
    s_nop 0
    buffer_load_dwordx4 v7, s[8:11], s25 offen offset:128 lds
    s_mov_b32 m0, s66
    s_nop 0
    buffer_load_dwordx4 v7, s[8:11], s25 offen offset:256 lds
    s_mov_b32 m0, s67
    s_nop 0
    buffer_load_dwordx4 v7, s[8:11], s25 offen offset:384 lds
    s_add_u32 s25, s25, 16384
    s_and_b32 s25, s25, 0x3ffff
    s_add_u32 s45, s31, 0
    s_add_u32 m0, s38, 0
    s_nop 0
    buffer_load_dwordx4 v7, s[4:7], s45 offen nt lds
    s_add_u32 m0, s38, 896
    s_nop 0
    buffer_load_dwordx4 v7, s[4:7], s45 offen offset:128 nt lds
    s_add_u32 m0, s38, 1792
    s_nop 0
    buffer_load_dwordx4 v7, s[4:7], s45 offen offset:256 nt lds
    s_add_u32 m0, s38, 2688
    s_nop 0
    buffer_load_dwordx4 v7, s[4:7], s45 offen offset:384 nt lds
    s_mov_b32 m0, s68
    s_nop 0
    buffer_load_dwordx4 v7, s[8:11], s25 offen lds
    s_mov_b32 m0, s69
    s_nop 0
    buffer_load_dwordx4 v7, s[8:11], s25 offen offset:128 lds
    s_mov_b32 m0, s70
    s_nop 0
    buffer_load_dwordx4 v7, s[8:11], s25 offen offset:256 lds
    s_mov_b32 m0, s71
    s_nop 0
    buffer_load_dwordx4 v7, s[8:11], s25 offen offset:384 lds
    s_add_u32 s25, s25, 16384
    s_and_b32 s25, s25, 0x3ffff
    v_and_b32 v34, 7, v0
    v_lshrrev_b32 v35, 4, v0
    v_and_b32 v36, 6, v0
    v_xor_b32 v37, v35, v36
    v_bfe_u32 v39, v0, 3, 1
    v_lshlrev_b32 v38, 12, v39
    v_lshl_add_u32 v38, v34, 7, v38
    v_lshl_add_u32 v1, v37, 4, v38
    v_xor_b32 v2, 64, v1
    v_mul_u32_u24 v39, 45056, v39
    v_add3_u32 v17, v1, s40, v39
    v_xor_b32 v18, 64, v17
    v_add_u32 v19, s38, v1
    v_xor_b32 v20, 64, v19
    v_bfe_u32 v34, v0, 2, 3
    v_and_b32 v35, 6, v34
    v_bfe_u32 v36, v0, 1, 1
    v_xor_b32 v35, v35, v36
    v_lshrrev_b32 v37, 5, v0
    v_lshlrev_b32 v37, 12, v37
    v_lshl_add_u32 v37, v34, 7, v37
    v_lshl_add_u32 v37, v35, 4, v37
    v_and_b32 v36, 1, v0
    v_lshl_add_u32 v37, v36, 3, v37
    v_add_u32 v3, 0x10000, v37
    v_xor_b32 v4, 32, v3
    v_xor_b32 v5, 64, v3
    v_xor_b32 v6, 0x60, v3
    v_lshrrev_b32 v34, 3, v0
    v_and_b32 v35, 7, v0
    v_lshlrev_b32 v36, 4, v35
    v_lshl_add_u32 v23, v34, 9, v36
    v_xor_b32 v35, v35, v34
    v_lshlrev_b32 v35, 4, v35
    v_lshl_add_u32 v35, v34, 7, v35
    v_add_u32 v24, s38, v35
    v_and_b32 v34, 15, v0
    v_lshrrev_b32 v35, 5, v0
    v_and_b32 v36, 7, v0
    v_xor_b32 v35, v35, v36
    v_lshlrev_b32 v35, 4, v35
    v_lshl_add_u32 v35, v34, 7, v35
    v_bfe_u32 v36, v0, 4, 1
    v_lshl_add_u32 v35, v36, 3, v35
    v_add_u32 v30, s38, v35
    v_xor_b32 v31, 32, v30
    v_xor_b32 v32, 64, v30
    v_xor_b32 v33, 0x60, v30
    s_sub_u32 s35, s33, s40
    s_lshl_b32 s39, s2, 13
    s_add_u32 s39, s39, s35
    s_and_b32 s39, s39, 0x3ffff
    v_and_b32 v34, 15, v0
    v_lshlrev_b32 v34, 7, v34
    v_add_u32 v29, s39, v34
    s_add_u32 s35, s38, 7168
    v_mov_b32 v21, s35
    v_and_b32 v34, 3, v0
    v_lshlrev_b32 v34, 13, v34
    v_add_u32 v22, 138240, v34
    s_cmp_eq_u32 s28, 0
    s_cselect_b32 s54, 0, 0
    s_mov_b32 s3, 0x30000
    s_mov_b32 s27, 0
    s_add_u32 s32, s31, 25165824
    s_mov_b32 s41, s32
    v_mov_b32 v14, 0
    v_mov_b32 v15, 0
    v_mov_b32 v16, 0
    s_add_u32 s46, s31, 4096
    s_add_u32 m0, s38, 4096
    s_nop 0
    buffer_load_dwordx4 v7, s[4:7], s46 offen nt lds
    s_add_u32 m0, s38, 4992
    s_nop 0
    buffer_load_dwordx4 v7, s[4:7], s46 offen offset:128 nt lds
    s_add_u32 m0, s38, 5888
    s_nop 0
    buffer_load_dwordx4 v7, s[4:7], s46 offen offset:256 nt lds
    s_add_u32 m0, s38, 6784
    s_nop 0
    buffer_load_dwordx4 v7, s[4:7], s46 offen offset:384 nt lds
    s_mov_b32 m0, s80
    s_nop 0
    buffer_load_dwordx4 v7, s[12:15], s26 offen lds
    s_mov_b32 m0, s81
    s_nop 0
    buffer_load_dwordx4 v7, s[12:15], s26 offen offset:128 lds
    s_mov_b32 m0, s82
    s_nop 0
    buffer_load_dwordx4 v7, s[12:15], s26 offen offset:256 lds
    s_mov_b32 m0, s83
    s_nop 0
    buffer_load_dwordx4 v7, s[12:15], s26 offen offset:384 lds
    s_add_u32 s26, s26, 16384
    s_and_b32 s26, s26, 0x3ffff
    s_add_u32 s45, s31, 8192
    s_mov_b32 m0, s76
    s_add_u32 s46, s31, 12288
    buffer_load_dwordx4 v7, s[4:7], s45 offen nt lds
    s_mov_b32 m0, s77
    s_nop 0
    buffer_load_dwordx4 v7, s[4:7], s45 offen offset:128 nt lds
    s_mov_b32 m0, s78
    s_nop 0
    buffer_load_dwordx4 v7, s[4:7], s45 offen offset:256 nt lds
    s_mov_b32 m0, s79
    s_nop 0
    buffer_load_dwordx4 v7, s[4:7], s45 offen offset:384 nt lds
    s_waitcnt vmcnt(12)
    s_barrier
    ds_read_b128 a[96:99], v1 offset:0
    ds_read_b128 a[100:103], v2 offset:0
    ds_read_b128 a[104:107], v1 offset:1024
    ds_read_b128 a[108:111], v2 offset:1024
    ds_read_b128 a[112:115], v1 offset:2048
    s_mov_b32 m0, s88
    ds_read_b128 a[116:119], v2 offset:2048
    ds_read_b128 a[120:123], v1 offset:3072
    ds_read_b128 a[124:127], v2 offset:3072
    ds_read_b128 a[128:131], v1 offset:8192
    ds_read_b128 a[132:135], v2 offset:8192
    ds_read_b128 a[136:139], v1 offset:9216
    ds_read_b128 a[140:143], v2 offset:9216
    ds_read_b128 a[144:147], v1 offset:10240
    ds_read_b128 a[148:151], v2 offset:10240
    ds_read_b128 a[152:155], v1 offset:11264
    ds_read_b128 a[156:159], v2 offset:11264
    ds_read_b128 a[224:227], v1 offset:16384
    ds_read_b128 a[228:231], v2 offset:16384
    ds_read_b128 a[232:235], v1 offset:17408
    ds_read_b128 a[236:239], v2 offset:17408
    ds_read_b128 a[240:243], v1 offset:18432
    ds_read_b128 a[244:247], v2 offset:18432
    ds_read_b128 a[248:251], v1 offset:19456
    ds_read_b128 a[252:255], v2 offset:19456
    ds_read_b128 a[160:163], v1 offset:24576
    ds_read_b128 a[164:167], v2 offset:24576
    ds_read_b128 a[168:171], v1 offset:25600
    ds_read_b128 a[172:175], v2 offset:25600
    ds_read_b128 a[176:179], v1 offset:26624
    ds_read_b128 a[180:183], v2 offset:26624
    ds_read_b128 a[184:187], v1 offset:27648
    ds_read_b128 a[188:191], v2 offset:27648
    buffer_load_dwordx4 v7, s[4:7], s46 offen nt lds
    s_mov_b32 m0, s89
    s_nop 0
    buffer_load_dwordx4 v7, s[4:7], s46 offen offset:128 nt lds
    s_mov_b32 m0, s90
    s_nop 0
    buffer_load_dwordx4 v7, s[4:7], s46 offen offset:256 nt lds
    s_mov_b32 m0, s91
    s_nop 0
    buffer_load_dwordx4 v7, s[4:7], s46 offen offset:384 nt lds
    s_mov_b32 m0, s72
    s_waitcnt vmcnt(12)
    ds_read_b128 a[0:3], v19 offset:0
    ds_read_b128 a[4:7], v20 offset:0
    ds_read_b128 a[8:11], v19 offset:1024
    ds_read_b128 a[12:15], v20 offset:1024
    ds_read_b128 a[16:19], v19 offset:2048
    ds_read_b128 a[20:23], v20 offset:2048
    ds_read_b128 a[24:27], v19 offset:3072
    ds_read_b128 a[28:31], v20 offset:3072
    s_waitcnt lgkmcnt(7)
    v_mfma_f32_16x16x32_bf16 v[48:51], a[96:99], a[0:3], 0
    s_waitcnt lgkmcnt(6)
    buffer_load_dwordx4 v7, s[8:11], s25 offen lds
    s_mov_b32 m0, s73
    v_mfma_f32_16x16x32_bf16 v[48:51], a[100:103], a[4:7], v[48:51]
    s_waitcnt lgkmcnt(5)
    v_mfma_f32_16x16x32_bf16 v[48:51], a[104:107], a[8:11], v[48:51]
    s_waitcnt lgkmcnt(4)
    v_mfma_f32_16x16x32_bf16 v[48:51], a[108:111], a[12:15], v[48:51]
    s_waitcnt lgkmcnt(3)
    v_mfma_f32_16x16x32_bf16 v[48:51], a[112:115], a[16:19], v[48:51]
    s_waitcnt lgkmcnt(2)
    buffer_load_dwordx4 v7, s[8:11], s25 offen offset:128 lds
    s_mov_b32 m0, s74
    v_mfma_f32_16x16x32_bf16 v[48:51], a[116:119], a[20:23], v[48:51]
    s_waitcnt lgkmcnt(1)
    v_mfma_f32_16x16x32_bf16 v[48:51], a[120:123], a[24:27], v[48:51]
    s_waitcnt lgkmcnt(0)
    v_mfma_f32_16x16x32_bf16 v[48:51], a[124:127], a[28:31], v[48:51]
    v_mfma_f32_16x16x32_bf16 v[60:63], a[128:131], a[0:3], 0
    buffer_load_dwordx4 v7, s[8:11], s25 offen offset:256 lds
    s_mov_b32 m0, s75
    v_mfma_f32_16x16x32_bf16 v[60:63], a[132:135], a[4:7], v[60:63]
    v_mfma_f32_16x16x32_bf16 v[60:63], a[136:139], a[8:11], v[60:63]
    v_mfma_f32_16x16x32_bf16 v[60:63], a[140:143], a[12:15], v[60:63]
    s_nop 1
    v_max3_f32 v34, v48, v49, v50
    v_mfma_f32_16x16x32_bf16 v[60:63], a[144:147], a[16:19], v[60:63]
    s_waitcnt vmcnt(11)
    buffer_load_dwordx4 v7, s[8:11], s25 offen offset:384 lds
    s_add_u32 s25, s25, 16384
    s_and_b32 s25, s25, 0x3ffff
    v_mfma_f32_16x16x32_bf16 v[60:63], a[148:151], a[20:23], v[60:63]
    s_barrier
    ds_read_b64_tr_b16 v[116:117], v3 offset:0
    ds_read_b64_tr_b16 v[118:119], v3 offset:8192
    v_mfma_f32_16x16x32_bf16 v[60:63], a[152:155], a[24:27], v[60:63]
    s_add_u32 s45, s31, 16384
    ds_read_b64_tr_b16 v[128:129], v4 offset:0
    ds_read_b64_tr_b16 v[130:131], v4 offset:8192
    v_mfma_f32_16x16x32_bf16 v[60:63], a[156:159], a[28:31], v[60:63]
    s_add_u32 s46, s31, 20480
    ds_read_b64_tr_b16 v[140:141], v5 offset:0
    ds_read_b64_tr_b16 v[142:143], v5 offset:8192
    ds_read_b64_tr_b16 v[152:153], v6 offset:0
    ds_read_b64_tr_b16 v[154:155], v6 offset:8192
    ds_read_b64_tr_b16 v[164:165], v3 offset:1024
    ds_read_b64_tr_b16 v[166:167], v3 offset:9216
    ds_read_b64_tr_b16 v[176:177], v4 offset:1024
    ds_read_b64_tr_b16 v[178:179], v4 offset:9216
    ds_read_b64_tr_b16 v[188:189], v5 offset:1024
    ds_read_b64_tr_b16 v[190:191], v5 offset:9216
    ds_read_b64_tr_b16 v[200:201], v6 offset:1024
    ds_read_b64_tr_b16 v[202:203], v6 offset:9216
    ds_read_b64_tr_b16 v[212:213], v3 offset:2048
    ds_read_b64_tr_b16 v[214:215], v3 offset:10240
    ds_read_b64_tr_b16 v[224:225], v4 offset:2048
    v_max3_f32 v35, v51, v60, v61
    s_add_u32 m0, s38, 0
    ds_read_b64_tr_b16 v[226:227], v4 offset:10240
    ds_read_b64_tr_b16 v[236:237], v5 offset:2048
    ds_read_b64_tr_b16 v[238:239], v5 offset:10240
    v_max3_f32 v34, v34, v62, v63
    ds_read_b64_tr_b16 v[248:249], v6 offset:2048
    ds_read_b64_tr_b16 v[250:251], v6 offset:10240
    ds_read_b64_tr_b16 a[196:197], v3 offset:3072
    v_max_f32 v34, v34, v35
    ds_read_b64_tr_b16 a[198:199], v3 offset:11264
    ds_read_b64_tr_b16 a[208:209], v4 offset:3072
    ds_read_b64_tr_b16 a[210:211], v4 offset:11264
    v_mov_b32 v35, v34
    ds_read_b64_tr_b16 a[220:221], v5 offset:3072
    ds_read_b64_tr_b16 a[222:223], v5 offset:11264
    ds_read_b64_tr_b16 v[40:41], v6 offset:3072
    v_permlane32_swap_b32 v34, v35
    v_max_f32 v34, v34, v35
    v_mov_b32 v35, v34
    ds_read_b64_tr_b16 v[42:43], v6 offset:11264
    v_mfma_f32_16x16x32_bf16 v[52:55], a[224:227], a[0:3], 0
    v_permlane16_swap_b32 v34, v35
    v_max_f32 v34, v34, v35
    v_mul_f32 v34, s30, v34
    v_cndmask_b32 v8, v34, v8, s[42:43]
    v_mfma_f32_16x16x32_bf16 v[52:55], a[228:231], a[4:7], v[52:55]
    v_fma_f32 v48, v48, s29, v8
    v_fma_f32 v49, v49, s29, v8
    v_mfma_f32_16x16x32_bf16 v[52:55], a[232:235], a[8:11], v[52:55]
    v_fma_f32 v50, v50, s29, v8
    v_fma_f32 v51, v51, s29, v8
    v_mfma_f32_16x16x32_bf16 v[52:55], a[236:239], a[12:15], v[52:55]
    v_exp_f32 v48, v48
    v_mfma_f32_16x16x32_bf16 v[52:55], a[240:243], a[16:19], v[52:55]
    v_exp_f32 v49, v49
    v_mfma_f32_16x16x32_bf16 v[52:55], a[244:247], a[20:23], v[52:55]
    v_exp_f32 v50, v50
    v_mfma_f32_16x16x32_bf16 v[52:55], a[248:251], a[24:27], v[52:55]
    v_exp_f32 v51, v51
    v_mfma_f32_16x16x32_bf16 v[52:55], a[252:255], a[28:31], v[52:55]
    v_cvt_pk_bf16_f32 v72, v48, v49
    v_add_f32 v14, v14, v48
    v_mfma_f32_16x16x32_bf16 v[64:67], a[160:163], a[0:3], 0
    v_add_f32 v14, v14, v49
    v_cvt_pk_bf16_f32 v73, v50, v51
    v_mfma_f32_16x16x32_bf16 v[64:67], a[164:167], a[4:7], v[64:67]
    v_add_f32 v14, v14, v50
    v_add_f32 v14, v14, v51
    v_mfma_f32_16x16x32_bf16 v[64:67], a[168:171], a[8:11], v[64:67]
    v_fma_f32 v60, v60, s29, v8
    v_fma_f32 v61, v61, s29, v8
    v_mfma_f32_16x16x32_bf16 v[64:67], a[172:175], a[12:15], v[64:67]
    v_fma_f32 v62, v62, s29, v8
    v_fma_f32 v63, v63, s29, v8
    v_mfma_f32_16x16x32_bf16 v[64:67], a[176:179], a[16:19], v[64:67]
    v_exp_f32 v60, v60
    v_mfma_f32_16x16x32_bf16 v[64:67], a[180:183], a[20:23], v[64:67]
    v_exp_f32 v61, v61
    v_mfma_f32_16x16x32_bf16 v[64:67], a[184:187], a[24:27], v[64:67]
    v_exp_f32 v62, v62
    v_mfma_f32_16x16x32_bf16 v[64:67], a[188:191], a[28:31], v[64:67]
    s_waitcnt lgkmcnt(0)
    v_exp_f32 v63, v63
    v_cvt_pk_bf16_f32 v74, v60, v61
    v_add_f32 v14, v14, v60
    v_add_f32 v14, v14, v61
    v_cvt_pk_bf16_f32 v75, v62, v63
    v_add_f32 v14, v14, v62
    v_add_f32 v14, v14, v63
    v_mfma_f32_16x16x32_bf16 v[96:99], v[116:119], v[72:75], 0
    v_fma_f32 v52, v52, s29, v8
    v_fma_f32 v53, v53, s29, v8
    v_mfma_f32_16x16x32_bf16 v[108:111], v[128:131], v[72:75], 0
    v_fma_f32 v54, v54, s29, v8
    v_fma_f32 v55, v55, s29, v8
    v_mfma_f32_16x16x32_bf16 v[120:123], v[140:143], v[72:75], 0
    v_exp_f32 v52, v52
    v_mfma_f32_16x16x32_bf16 v[132:135], v[152:155], v[72:75], 0
    v_exp_f32 v53, v53
    v_mfma_f32_16x16x32_bf16 v[144:147], v[164:167], v[72:75], 0
    v_exp_f32 v54, v54
    v_mfma_f32_16x16x32_bf16 v[156:159], v[176:179], v[72:75], 0
    v_exp_f32 v55, v55
    v_mfma_f32_16x16x32_bf16 v[168:171], v[188:191], v[72:75], 0
    v_cvt_pk_bf16_f32 v84, v52, v53
    v_add_f32 v14, v14, v52
    v_mfma_f32_16x16x32_bf16 v[180:183], v[200:203], v[72:75], 0
    v_add_f32 v14, v14, v53
    v_cvt_pk_bf16_f32 v85, v54, v55
    v_mfma_f32_16x16x32_bf16 v[192:195], v[212:215], v[72:75], 0
    v_add_f32 v14, v14, v54
    v_add_f32 v14, v14, v55
    v_mfma_f32_16x16x32_bf16 v[204:207], v[224:227], v[72:75], 0
    v_fma_f32 v64, v64, s29, v8
    v_fma_f32 v65, v65, s29, v8
    v_mfma_f32_16x16x32_bf16 v[216:219], v[236:239], v[72:75], 0
    v_fma_f32 v66, v66, s29, v8
    v_fma_f32 v67, v67, s29, v8
    v_mfma_f32_16x16x32_bf16 v[228:231], v[248:251], v[72:75], 0
    v_exp_f32 v64, v64
    v_mfma_f32_16x16x32_bf16 v[240:243], a[196:199], v[72:75], 0
    v_exp_f32 v65, v65
    v_mfma_f32_16x16x32_bf16 v[252:255], a[208:211], v[72:75], 0
    v_exp_f32 v66, v66
    v_mfma_f32_16x16x32_bf16 a[200:203], a[220:223], v[72:75], 0
    v_exp_f32 v67, v67
    v_mfma_f32_16x16x32_bf16 a[212:215], v[40:43], v[72:75], 0
    v_cvt_pk_bf16_f32 v86, v64, v65
    v_add_f32 v14, v14, v64
    v_add_f32 v14, v14, v65
    v_cvt_pk_bf16_f32 v87, v66, v67
    v_add_f32 v14, v14, v66
    v_add_f32 v14, v14, v67
    buffer_load_dwordx4 v7, s[4:7], s45 offen nt lds
    s_add_u32 m0, s38, 4096
    s_nop 0
    buffer_load_dwordx4 v7, s[4:7], s46 offen nt lds
    s_add_u32 m0, s38, 896
    s_nop 0
    buffer_load_dwordx4 v7, s[4:7], s45 offen offset:128 nt lds
    s_add_u32 m0, s38, 4992
    s_nop 0
    buffer_load_dwordx4 v7, s[4:7], s46 offen offset:128 nt lds
    s_mov_b32 m0, s84
    s_nop 0
    buffer_load_dwordx4 v7, s[12:15], s26 offen lds
    s_mov_b32 m0, s85
    s_nop 0
    buffer_load_dwordx4 v7, s[12:15], s26 offen offset:128 lds
    s_mov_b32 m0, s86
    s_nop 0
    buffer_load_dwordx4 v7, s[12:15], s26 offen offset:256 lds
    s_mov_b32 m0, s87
    s_nop 0
    buffer_load_dwordx4 v7, s[12:15], s26 offen offset:384 lds
    s_add_u32 s26, s26, 16384
    s_and_b32 s26, s26, 0x3ffff
    s_add_u32 m0, s38, 1792
    s_waitcnt vmcnt(12)
    ds_read_b128 a[32:35], v17 offset:49152
    ds_read_b128 a[36:39], v18 offset:49152
    ds_read_b128 a[40:43], v17 offset:50176
    ds_read_b128 a[44:47], v18 offset:50176
    ds_read_b128 a[48:51], v17 offset:51200
    ds_read_b128 a[52:55], v18 offset:51200
    ds_read_b128 a[56:59], v17 offset:52224
    ds_read_b128 a[60:63], v18 offset:52224
    buffer_load_dwordx4 v7, s[4:7], s45 offen offset:256 nt lds
    s_add_u32 m0, s38, 5888
    s_waitcnt lgkmcnt(7)
    v_mfma_f32_16x16x32_bf16 v[48:51], a[96:99], a[32:35], 0
    s_waitcnt lgkmcnt(6)
    v_mfma_f32_16x16x32_bf16 v[48:51], a[100:103], a[36:39], v[48:51]
    s_waitcnt lgkmcnt(5)
    v_mfma_f32_16x16x32_bf16 v[48:51], a[104:107], a[40:43], v[48:51]
    s_waitcnt lgkmcnt(4)
    v_mfma_f32_16x16x32_bf16 v[48:51], a[108:111], a[44:47], v[48:51]
    s_waitcnt lgkmcnt(3)
    buffer_load_dwordx4 v7, s[4:7], s46 offen offset:256 nt lds
    s_add_u32 m0, s38, 2688
    v_mfma_f32_16x16x32_bf16 v[48:51], a[112:115], a[48:51], v[48:51]
    s_waitcnt lgkmcnt(2)
    v_mfma_f32_16x16x32_bf16 v[48:51], a[116:119], a[52:55], v[48:51]
    s_waitcnt lgkmcnt(1)
    v_mfma_f32_16x16x32_bf16 v[48:51], a[120:123], a[56:59], v[48:51]
    s_waitcnt lgkmcnt(0)
    v_mfma_f32_16x16x32_bf16 v[48:51], a[124:127], a[60:63], v[48:51]
    buffer_load_dwordx4 v7, s[4:7], s45 offen offset:384 nt lds
    s_add_u32 m0, s38, 6784
    v_mfma_f32_16x16x32_bf16 v[60:63], a[128:131], a[32:35], 0
    v_mfma_f32_16x16x32_bf16 v[60:63], a[132:135], a[36:39], v[60:63]
    v_mfma_f32_16x16x32_bf16 v[60:63], a[136:139], a[40:43], v[60:63]
    v_mfma_f32_16x16x32_bf16 v[60:63], a[140:143], a[44:47], v[60:63]
    buffer_load_dwordx4 v7, s[4:7], s46 offen offset:384 nt lds
    v_mfma_f32_16x16x32_bf16 v[60:63], a[144:147], a[48:51], v[60:63]
    s_mov_b32 m0, s76
    v_max3_f32 v36, v48, v49, v50
    v_mfma_f32_16x16x32_bf16 v[60:63], a[148:151], a[52:55], v[60:63]
    v_mfma_f32_16x16x32_bf16 v[60:63], a[152:155], a[56:59], v[60:63]
    v_mfma_f32_16x16x32_bf16 v[60:63], a[156:159], a[60:63], v[60:63]
    v_mfma_f32_16x16x32_bf16 v[52:55], a[224:227], a[32:35], 0
    v_mfma_f32_16x16x32_bf16 v[52:55], a[228:231], a[36:39], v[52:55]
    v_mfma_f32_16x16x32_bf16 v[52:55], a[232:235], a[40:43], v[52:55]
    v_mfma_f32_16x16x32_bf16 v[52:55], a[236:239], a[44:47], v[52:55]
    v_mfma_f32_16x16x32_bf16 v[52:55], a[240:243], a[48:51], v[52:55]
    v_mfma_f32_16x16x32_bf16 v[52:55], a[244:247], a[52:55], v[52:55]
    s_nop 1
    v_max3_f32 v37, v51, v60, v61
    v_mfma_f32_16x16x32_bf16 v[52:55], a[248:251], a[56:59], v[52:55]
    v_max3_f32 v36, v36, v62, v63
    v_max_f32 v36, v36, v37
    v_mov_b32 v37, v36
    v_mfma_f32_16x16x32_bf16 v[52:55], a[252:255], a[60:63], v[52:55]
    s_nop 0
    v_permlane32_swap_b32 v36, v37
    v_max_f32 v36, v36, v37
    v_mov_b32 v37, v36
    v_mfma_f32_16x16x32_bf16 v[64:67], a[160:163], a[32:35], 0
    s_nop 0
    v_permlane16_swap_b32 v36, v37
    v_max_f32 v36, v36, v37
    v_mul_f32 v36, s30, v36
    v_cndmask_b32 v9, v36, v9, s[42:43]
    v_mfma_f32_16x16x32_bf16 v[64:67], a[164:167], a[36:39], v[64:67]
    v_fma_f32 v48, v48, s29, v9
    v_fma_f32 v49, v49, s29, v9
    v_mfma_f32_16x16x32_bf16 v[64:67], a[168:171], a[40:43], v[64:67]
    v_fma_f32 v50, v50, s29, v9
    v_fma_f32 v51, v51, s29, v9
    v_mfma_f32_16x16x32_bf16 v[64:67], a[172:175], a[44:47], v[64:67]
    v_exp_f32 v48, v48
    v_mfma_f32_16x16x32_bf16 v[64:67], a[176:179], a[48:51], v[64:67]
    v_exp_f32 v49, v49
    v_mfma_f32_16x16x32_bf16 v[64:67], a[180:183], a[52:55], v[64:67]
    v_exp_f32 v50, v50
    v_mfma_f32_16x16x32_bf16 v[64:67], a[184:187], a[56:59], v[64:67]
    v_exp_f32 v51, v51
    v_mfma_f32_16x16x32_bf16 v[64:67], a[188:191], a[60:63], v[64:67]
    v_cvt_pk_bf16_f32 v72, v48, v49
    v_add_f32 v15, v15, v48
    v_add_f32 v15, v15, v49
    v_cvt_pk_bf16_f32 v73, v50, v51
    v_add_f32 v15, v15, v50
    v_add_f32 v15, v15, v51
    v_fma_f32 v60, v60, s29, v9
    v_fma_f32 v61, v61, s29, v9
    v_fma_f32 v62, v62, s29, v9
    v_fma_f32 v63, v63, s29, v9
    v_exp_f32 v60, v60
    v_exp_f32 v61, v61
    v_exp_f32 v62, v62
    v_exp_f32 v63, v63
    v_cvt_pk_bf16_f32 v74, v60, v61
    v_add_f32 v15, v15, v60
    v_add_f32 v15, v15, v61
    v_cvt_pk_bf16_f32 v75, v62, v63
    v_add_f32 v15, v15, v62
    v_add_f32 v15, v15, v63
    v_mfma_f32_16x16x32_bf16 v[100:103], v[116:119], v[72:75], 0
    v_fma_f32 v52, v52, s29, v9
    v_fma_f32 v53, v53, s29, v9
    v_mfma_f32_16x16x32_bf16 v[112:115], v[128:131], v[72:75], 0
    v_fma_f32 v54, v54, s29, v9
    v_fma_f32 v55, v55, s29, v9
    v_mfma_f32_16x16x32_bf16 v[124:127], v[140:143], v[72:75], 0
    v_exp_f32 v52, v52
    v_mfma_f32_16x16x32_bf16 v[136:139], v[152:155], v[72:75], 0
    v_exp_f32 v53, v53
    v_mfma_f32_16x16x32_bf16 v[148:151], v[164:167], v[72:75], 0
    v_exp_f32 v54, v54
    v_mfma_f32_16x16x32_bf16 v[160:163], v[176:179], v[72:75], 0
    v_exp_f32 v55, v55
    v_mfma_f32_16x16x32_bf16 v[172:175], v[188:191], v[72:75], 0
    v_cvt_pk_bf16_f32 v88, v52, v53
    v_add_f32 v15, v15, v52
    v_mfma_f32_16x16x32_bf16 v[184:187], v[200:203], v[72:75], 0
    v_add_f32 v15, v15, v53
    v_cvt_pk_bf16_f32 v89, v54, v55
    v_mfma_f32_16x16x32_bf16 v[196:199], v[212:215], v[72:75], 0
    v_add_f32 v15, v15, v54
    v_add_f32 v15, v15, v55
    v_mfma_f32_16x16x32_bf16 v[208:211], v[224:227], v[72:75], 0
    v_fma_f32 v64, v64, s29, v9
    v_fma_f32 v65, v65, s29, v9
    v_mfma_f32_16x16x32_bf16 v[220:223], v[236:239], v[72:75], 0
    v_fma_f32 v66, v66, s29, v9
    v_fma_f32 v67, v67, s29, v9
    v_mfma_f32_16x16x32_bf16 v[232:235], v[248:251], v[72:75], 0
    v_exp_f32 v64, v64
    v_mfma_f32_16x16x32_bf16 v[244:247], a[196:199], v[72:75], 0
    s_waitcnt vmcnt(10)
    v_exp_f32 v65, v65
    v_mfma_f32_16x16x32_bf16 a[192:195], a[208:211], v[72:75], 0
    v_exp_f32 v66, v66
    v_mfma_f32_16x16x32_bf16 a[204:207], a[220:223], v[72:75], 0
    v_exp_f32 v67, v67
    v_mfma_f32_16x16x32_bf16 a[216:219], v[40:43], v[72:75], 0
    v_cvt_pk_bf16_f32 v90, v64, v65
    v_add_f32 v15, v15, v64
    v_add_f32 v15, v15, v65
    v_cvt_pk_bf16_f32 v91, v66, v67
    v_add_f32 v15, v15, v66
    v_add_f32 v15, v15, v67
    ds_read_b128 a[64:67], v19 offset:0
    ds_read_b128 a[68:71], v20 offset:0
    s_waitcnt lgkmcnt(1)
    v_mfma_f32_16x16x32_bf16 v[48:51], a[96:99], a[64:67], 0
    s_waitcnt lgkmcnt(0)
    v_mfma_f32_16x16x32_bf16 v[48:51], a[100:103], a[68:71], v[48:51]
    v_mfma_f32_16x16x32_bf16 v[60:63], a[128:131], a[64:67], 0
    v_mfma_f32_16x16x32_bf16 v[60:63], a[132:135], a[68:71], v[60:63]
    v_mfma_f32_16x16x32_bf16 v[52:55], a[224:227], a[64:67], 0
    v_mfma_f32_16x16x32_bf16 v[52:55], a[228:231], a[68:71], v[52:55]
    v_mfma_f32_16x16x32_bf16 v[64:67], a[160:163], a[64:67], 0
    v_mfma_f32_16x16x32_bf16 v[64:67], a[164:167], a[68:71], v[64:67]
    buffer_load_dwordx4 v7, s[8:11], s25 offen lds
    s_mov_b32 m0, s77
    s_nop 0
    buffer_load_dwordx4 v7, s[8:11], s25 offen offset:128 lds
    s_mov_b32 m0, s78
    s_nop 0
    buffer_load_dwordx4 v7, s[8:11], s25 offen offset:256 lds
    s_mov_b32 m0, s79
    s_nop 0
    buffer_load_dwordx4 v7, s[8:11], s25 offen offset:384 lds
    s_add_u32 s25, s25, 16384
    s_and_b32 s25, s25, 0x3ffff
    s_mov_b32 m0, s88
    s_waitcnt vmcnt(12)
    ds_read_b128 a[72:75], v19 offset:1024
    ds_read_b128 a[76:79], v20 offset:1024
    buffer_load_dwordx4 v7, s[12:15], s26 offen lds
    s_mov_b32 m0, s89
    s_waitcnt lgkmcnt(1)
    v_mfma_f32_16x16x32_bf16 v[48:51], a[104:107], a[72:75], v[48:51]
    s_waitcnt lgkmcnt(0)
    v_mfma_f32_16x16x32_bf16 v[48:51], a[108:111], a[76:79], v[48:51]
    v_mfma_f32_16x16x32_bf16 v[60:63], a[136:139], a[72:75], v[60:63]
    v_mfma_f32_16x16x32_bf16 v[60:63], a[140:143], a[76:79], v[60:63]
    buffer_load_dwordx4 v7, s[12:15], s26 offen offset:128 lds
    s_mov_b32 m0, s90
    v_mfma_f32_16x16x32_bf16 v[52:55], a[232:235], a[72:75], v[52:55]
    v_mfma_f32_16x16x32_bf16 v[52:55], a[236:239], a[76:79], v[52:55]
    v_mfma_f32_16x16x32_bf16 v[64:67], a[168:171], a[72:75], v[64:67]
    v_mfma_f32_16x16x32_bf16 v[64:67], a[172:175], a[76:79], v[64:67]
    buffer_load_dwordx4 v7, s[12:15], s26 offen offset:256 lds
    s_mov_b32 m0, s91
    s_nop 0
    buffer_load_dwordx4 v7, s[12:15], s26 offen offset:384 lds
    s_add_u32 s26, s26, 16384
    s_and_b32 s26, s26, 0x3ffff
    s_mov_b32 m0, s64
    s_waitcnt vmcnt(10)
    ds_read_b128 a[80:83], v19 offset:2048
    ds_read_b128 a[84:87], v20 offset:2048
    s_waitcnt lgkmcnt(1)
    v_mfma_f32_16x16x32_bf16 v[48:51], a[112:115], a[80:83], v[48:51]
    s_waitcnt lgkmcnt(0)
    v_mfma_f32_16x16x32_bf16 v[48:51], a[116:119], a[84:87], v[48:51]
    v_mfma_f32_16x16x32_bf16 v[60:63], a[144:147], a[80:83], v[60:63]
    v_mfma_f32_16x16x32_bf16 v[60:63], a[148:151], a[84:87], v[60:63]
    v_mfma_f32_16x16x32_bf16 v[52:55], a[240:243], a[80:83], v[52:55]
    v_mfma_f32_16x16x32_bf16 v[52:55], a[244:247], a[84:87], v[52:55]
    v_mfma_f32_16x16x32_bf16 v[64:67], a[176:179], a[80:83], v[64:67]
    v_mfma_f32_16x16x32_bf16 v[64:67], a[180:183], a[84:87], v[64:67]
    buffer_load_dwordx4 v7, s[8:11], s25 offen lds
    s_mov_b32 m0, s65
    s_nop 0
    buffer_load_dwordx4 v7, s[8:11], s25 offen offset:128 lds
    s_mov_b32 m0, s66
    s_nop 0
    buffer_load_dwordx4 v7, s[8:11], s25 offen offset:256 lds
    s_mov_b32 m0, s67
    s_nop 0
    buffer_load_dwordx4 v7, s[8:11], s25 offen offset:384 lds
    s_add_u32 s25, s25, 16384
    s_and_b32 s25, s25, 0x3ffff
    s_mov_b32 m0, s92
    s_waitcnt vmcnt(12)
    ds_read_b128 a[88:91], v19 offset:3072
    ds_read_b128 a[92:95], v20 offset:3072
    buffer_load_dwordx4 v7, s[12:15], s26 offen lds
    s_mov_b32 m0, s93
    s_waitcnt lgkmcnt(1)
    v_mfma_f32_16x16x32_bf16 v[48:51], a[120:123], a[88:91], v[48:51]
    s_waitcnt lgkmcnt(0)
    v_mfma_f32_16x16x32_bf16 v[48:51], a[124:127], a[92:95], v[48:51]
    v_mfma_f32_16x16x32_bf16 v[60:63], a[152:155], a[88:91], v[60:63]
    v_mfma_f32_16x16x32_bf16 v[60:63], a[156:159], a[92:95], v[60:63]
    buffer_load_dwordx4 v7, s[12:15], s26 offen offset:128 lds
    s_mov_b32 m0, s94
    v_mfma_f32_16x16x32_bf16 v[52:55], a[248:251], a[88:91], v[52:55]
    v_mfma_f32_16x16x32_bf16 v[52:55], a[252:255], a[92:95], v[52:55]
    s_nop 1
    v_max3_f32 v38, v48, v49, v50
    v_mfma_f32_16x16x32_bf16 v[64:67], a[184:187], a[88:91], v[64:67]
    v_max3_f32 v39, v51, v60, v61
    v_mfma_f32_16x16x32_bf16 v[64:67], a[188:191], a[92:95], v[64:67]
    buffer_load_dwordx4 v7, s[12:15], s26 offen offset:256 lds
    s_mov_b32 m0, s95
    v_max3_f32 v38, v38, v62, v63
    v_max_f32 v38, v38, v39
    v_mov_b32 v39, v38
    s_nop 1
    v_permlane32_swap_b32 v38, v39
    v_max_f32 v38, v38, v39
    v_mov_b32 v39, v38
    s_nop 1
    v_permlane16_swap_b32 v38, v39
    buffer_load_dwordx4 v7, s[12:15], s26 offen offset:384 lds
    s_add_u32 s26, s26, 16384
    s_and_b32 s26, s26, 0x3ffff
    v_max_f32 v38, v38, v39
    v_mul_f32 v38, s30, v38
    v_cndmask_b32 v10, v38, v10, s[42:43]
    v_fma_f32 v48, v48, s29, v10
    v_fma_f32 v49, v49, s29, v10
    v_fma_f32 v50, v50, s29, v10
    v_fma_f32 v51, v51, s29, v10
    v_exp_f32 v48, v48
    v_exp_f32 v49, v49
    v_exp_f32 v50, v50
    v_exp_f32 v51, v51
    v_cvt_pk_bf16_f32 v72, v48, v49
    v_add_f32 v16, v16, v48
    v_add_f32 v16, v16, v49
    v_cvt_pk_bf16_f32 v73, v50, v51
    v_add_f32 v16, v16, v50
    v_add_f32 v16, v16, v51
    v_fma_f32 v60, v60, s29, v10
    v_fma_f32 v61, v61, s29, v10
    v_fma_f32 v62, v62, s29, v10
    v_fma_f32 v63, v63, s29, v10
    v_exp_f32 v60, v60
    v_exp_f32 v61, v61
    v_exp_f32 v62, v62
    v_exp_f32 v63, v63
    v_cvt_pk_bf16_f32 v74, v60, v61
    v_add_f32 v16, v16, v60
    v_add_f32 v16, v16, v61
    v_cvt_pk_bf16_f32 v75, v62, v63
    v_add_f32 v16, v16, v62
    v_add_f32 v16, v16, v63
    s_waitcnt vmcnt(20)
    s_barrier
    ds_read_b128 a[96:99], v1 offset:32768
    ds_read_b128 a[100:103], v2 offset:32768
    ds_read_b128 a[104:107], v1 offset:33792
    ds_read_b128 a[108:111], v2 offset:33792
    ds_read_b128 a[112:115], v1 offset:34816
    v_mfma_f32_16x16x32_bf16 v[104:107], v[116:119], v[72:75], 0
    ds_read_b128 a[116:119], v2 offset:34816
    v_fma_f32 v52, v52, s29, v10
    v_mfma_f32_16x16x32_bf16 v[116:119], v[128:131], v[72:75], 0
    ds_read_b128 a[120:123], v1 offset:35840
    v_fma_f32 v53, v53, s29, v10
    v_mfma_f32_16x16x32_bf16 v[128:131], v[140:143], v[72:75], 0
    ds_read_b128 a[124:127], v2 offset:35840
    v_fma_f32 v54, v54, s29, v10
    v_mfma_f32_16x16x32_bf16 v[140:143], v[152:155], v[72:75], 0
    v_fma_f32 v55, v55, s29, v10
    v_fma_f32 v64, v64, s29, v10
    v_mfma_f32_16x16x32_bf16 v[152:155], v[164:167], v[72:75], 0
    v_exp_f32 v52, v52
    v_mfma_f32_16x16x32_bf16 v[164:167], v[176:179], v[72:75], 0
    v_exp_f32 v53, v53
    v_mfma_f32_16x16x32_bf16 v[176:179], v[188:191], v[72:75], 0
    v_exp_f32 v54, v54
    v_mfma_f32_16x16x32_bf16 v[188:191], v[200:203], v[72:75], 0
    v_exp_f32 v55, v55
    v_mfma_f32_16x16x32_bf16 v[200:203], v[212:215], v[72:75], 0
    v_cvt_pk_bf16_f32 v92, v52, v53
    v_add_f32 v16, v16, v52
    v_mfma_f32_16x16x32_bf16 v[212:215], v[224:227], v[72:75], 0
    v_add_f32 v16, v16, v53
    v_cvt_pk_bf16_f32 v93, v54, v55
    v_mfma_f32_16x16x32_bf16 v[224:227], v[236:239], v[72:75], 0
    v_add_f32 v16, v16, v54
    v_add_f32 v16, v16, v55
    v_mfma_f32_16x16x32_bf16 v[236:239], v[248:251], v[72:75], 0
    v_fma_f32 v65, v65, s29, v10
    v_fma_f32 v66, v66, s29, v10
    v_mfma_f32_16x16x32_bf16 v[248:251], a[196:199], v[72:75], 0
    v_fma_f32 v67, v67, s29, v10
    v_exp_f32 v64, v64
    v_mfma_f32_16x16x32_bf16 a[196:199], a[208:211], v[72:75], 0
    v_exp_f32 v65, v65
    v_mfma_f32_16x16x32_bf16 a[208:211], a[220:223], v[72:75], 0
    v_exp_f32 v66, v66
    v_mfma_f32_16x16x32_bf16 a[220:223], v[40:43], v[72:75], 0
    v_exp_f32 v67, v67
    v_cvt_pk_bf16_f32 v94, v64, v65
    v_add_f32 v16, v16, v64
    v_add_f32 v16, v16, v65
    v_cvt_pk_bf16_f32 v95, v66, v67
    v_add_f32 v16, v16, v66
    v_add_f32 v16, v16, v67
    s_cmp_eq_u32 s28, 0
    s_cselect_b32 s45, 16777216, 0
    s_cselect_b32 s34, 0, 0
    s_mov_b32 s39, 0
    s_add_u32 s20, s50, s45
    s_addc_u32 s21, s51, 0
    s_waitcnt lgkmcnt(0)
L_u1:
    v_mfma_f32_16x16x32_bf16 v[48:51], a[96:99], a[0:3], 0
    s_mov_b32 m0, s68
    ds_read_b128 a[128:131], v1 offset:40960
    v_mfma_f32_16x16x32_bf16 v[48:51], a[100:103], a[4:7], v[48:51]
    buffer_load_dwordx4 v7, s[8:11], s25 offen lds
    v_mfma_f32_16x16x32_bf16 v[48:51], a[104:107], a[8:11], v[48:51]
    s_mov_b32 m0, s69
    ds_read_b128 a[132:135], v2 offset:40960
    v_mfma_f32_16x16x32_bf16 v[48:51], a[108:111], a[12:15], v[48:51]
    ds_read_b128 a[136:139], v1 offset:41984
    v_mfma_f32_16x16x32_bf16 v[48:51], a[112:115], a[16:19], v[48:51]
    buffer_load_dwordx4 v7, s[8:11], s25 offen offset:128 lds
    v_mfma_f32_16x16x32_bf16 v[48:51], a[116:119], a[20:23], v[48:51]
    s_mov_b32 m0, s70
    ds_read_b128 a[140:143], v2 offset:41984
    v_mfma_f32_16x16x32_bf16 v[48:51], a[120:123], a[24:27], v[48:51]
    ds_read_b128 a[144:147], v1 offset:43008
    v_mfma_f32_16x16x32_bf16 v[48:51], a[124:127], a[28:31], v[48:51]
    buffer_load_dwordx4 v7, s[8:11], s25 offen offset:256 lds
    v_mfma_f32_16x16x32_bf16 v[52:55], a[124:127], a[60:63], 0
    s_mov_b32 m0, s71
    ds_read_b128 a[148:151], v2 offset:43008
    v_mfma_f32_16x16x32_bf16 v[52:55], a[120:123], a[56:59], v[52:55]
    ds_read_b128 a[152:155], v1 offset:44032
    v_mfma_f32_16x16x32_bf16 v[52:55], a[116:119], a[52:55], v[52:55]
    buffer_load_dwordx4 v7, s[8:11], s25 offen offset:384 lds
    v_mfma_f32_16x16x32_bf16 v[52:55], a[112:115], a[48:51], v[52:55]
    s_mov_b32 m0, s80
    ds_read_b128 a[156:159], v2 offset:44032
    v_fma_f32 v48, v48, s29, v8
    v_mfma_f32_16x16x32_bf16 v[52:55], a[108:111], a[44:47], v[52:55]
    s_add_u32 s25, s25, 16384
    buffer_load_dwordx4 v7, s[12:15], s26 offen lds
    v_mfma_f32_16x16x32_bf16 v[52:55], a[104:107], a[40:43], v[52:55]
    s_mov_b32 m0, s81
    v_fma_f32 v49, v49, s29, v8
    v_fma_f32 v50, v50, s29, v8
    v_mfma_f32_16x16x32_bf16 v[52:55], a[100:103], a[36:39], v[52:55]
    s_and_b32 s25, s25, 0x3ffff
    v_fma_f32 v51, v51, s29, v8
    v_mfma_f32_16x16x32_bf16 v[52:55], a[96:99], a[32:35], v[52:55]
    s_mov_b32 s22, s34
    v_exp_f32 v48, v48
    v_mfma_f32_16x16x32_bf16 v[56:59], a[96:99], a[64:67], 0
    v_exp_f32 v49, v49
    v_mfma_f32_16x16x32_bf16 v[56:59], a[100:103], a[68:71], v[56:59]
    v_exp_f32 v50, v50
    v_mfma_f32_16x16x32_bf16 v[56:59], a[104:107], a[72:75], v[56:59]
    v_exp_f32 v51, v51
    v_mfma_f32_16x16x32_bf16 v[56:59], a[108:111], a[76:79], v[56:59]
    v_add_f32 v14, v14, v48
    v_cvt_pk_bf16_f32 v72, v48, v49
    v_mfma_f32_16x16x32_bf16 v[56:59], a[112:115], a[80:83], v[56:59]
    buffer_load_dwordx4 v7, s[12:15], s26 offen offset:128 lds
    v_mfma_f32_16x16x32_bf16 v[56:59], a[116:119], a[84:87], v[56:59]
    s_mov_b32 m0, s82
    v_add_f32 v14, v14, v49
    v_add_f32 v14, v14, v50
    v_mfma_f32_16x16x32_bf16 v[56:59], a[120:123], a[88:91], v[56:59]
    v_cvt_pk_bf16_f32 v73, v50, v51
    v_add_f32 v14, v14, v51
    v_mfma_f32_16x16x32_bf16 v[56:59], a[124:127], a[92:95], v[56:59]
    s_waitcnt lgkmcnt(0)
    v_fma_f32 v52, v52, s29, v9
    v_fma_f32 v53, v53, s29, v9
    v_mfma_f32_16x16x32_bf16 v[60:63], a[128:131], a[0:3], 0
    v_fma_f32 v54, v54, s29, v9
    v_fma_f32 v55, v55, s29, v9
    v_mfma_f32_16x16x32_bf16 v[60:63], a[132:135], a[4:7], v[60:63]
    v_exp_f32 v52, v52
    v_mfma_f32_16x16x32_bf16 v[60:63], a[136:139], a[8:11], v[60:63]
    v_exp_f32 v53, v53
    v_mfma_f32_16x16x32_bf16 v[60:63], a[140:143], a[12:15], v[60:63]
    v_exp_f32 v54, v54
    v_mfma_f32_16x16x32_bf16 v[60:63], a[144:147], a[16:19], v[60:63]
    v_exp_f32 v55, v55
    v_mfma_f32_16x16x32_bf16 v[60:63], a[148:151], a[20:23], v[60:63]
    ds_read_b64_tr_b16 a[160:161], v3 offset:16384
    ds_read_b64_tr_b16 a[162:163], v3 offset:24576
    v_mfma_f32_16x16x32_bf16 v[60:63], a[152:155], a[24:27], v[60:63]
    global_load_dword v44, v25, s[0:1]
    v_mfma_f32_16x16x32_bf16 v[60:63], a[156:159], a[28:31], v[60:63]
    v_add_f32 v15, v15, v52
    v_cvt_pk_bf16_f32 v76, v52, v53
    v_mfma_f32_16x16x32_bf16 v[64:67], a[156:159], a[60:63], 0
    ds_read_b64_tr_b16 a[164:165], v4 offset:16384
    ds_read_b64_tr_b16 a[166:167], v4 offset:24576
    v_mfma_f32_16x16x32_bf16 v[64:67], a[152:155], a[56:59], v[64:67]
    v_add_f32 v15, v15, v53
    v_add_f32 v15, v15, v54
    v_mfma_f32_16x16x32_bf16 v[64:67], a[148:151], a[52:55], v[64:67]
    v_cvt_pk_bf16_f32 v77, v54, v55
    v_add_f32 v15, v15, v55
    v_mfma_f32_16x16x32_bf16 v[64:67], a[144:147], a[48:51], v[64:67]
    ds_read_b64_tr_b16 a[168:169], v5 offset:16384
    ds_read_b64_tr_b16 a[170:171], v5 offset:24576
    v_mfma_f32_16x16x32_bf16 v[64:67], a[140:143], a[44:47], v[64:67]
    v_fma_f32 v56, v56, s29, v10
    v_fma_f32 v57, v57, s29, v10
    v_mfma_f32_16x16x32_bf16 v[64:67], a[136:139], a[40:43], v[64:67]
    v_fma_f32 v58, v58, s29, v10
    v_fma_f32 v59, v59, s29, v10
    v_mfma_f32_16x16x32_bf16 v[64:67], a[132:135], a[36:39], v[64:67]
    ds_read_b64_tr_b16 a[172:173], v6 offset:16384
    ds_read_b64_tr_b16 a[174:175], v6 offset:24576
    v_mfma_f32_16x16x32_bf16 v[64:67], a[128:131], a[32:35], v[64:67]
    v_exp_f32 v56, v56
    v_mfma_f32_16x16x32_bf16 v[68:71], a[128:131], a[64:67], 0
    buffer_load_dwordx4 v7, s[12:15], s26 offen offset:256 lds
    v_mfma_f32_16x16x32_bf16 v[68:71], a[132:135], a[68:71], v[68:71]
    s_mov_b32 m0, s83
    ds_read_b64_tr_b16 a[176:177], v3 offset:17408
    ds_read_b64_tr_b16 a[178:179], v3 offset:25600
    v_mfma_f32_16x16x32_bf16 v[68:71], a[136:139], a[72:75], v[68:71]
    v_exp_f32 v57, v57
    v_mfma_f32_16x16x32_bf16 v[68:71], a[140:143], a[76:79], v[68:71]
    v_exp_f32 v58, v58
    v_mfma_f32_16x16x32_bf16 v[68:71], a[144:147], a[80:83], v[68:71]
    ds_read_b64_tr_b16 a[180:181], v4 offset:17408
    ds_read_b64_tr_b16 a[182:183], v4 offset:25600
    v_mfma_f32_16x16x32_bf16 v[68:71], a[148:151], a[84:87], v[68:71]
    v_exp_f32 v59, v59
    v_mfma_f32_16x16x32_bf16 v[68:71], a[152:155], a[88:91], v[68:71]
    v_add_f32 v16, v16, v56
    v_cvt_pk_bf16_f32 v80, v56, v57
    v_mfma_f32_16x16x32_bf16 v[68:71], a[156:159], a[92:95], v[68:71]
    s_waitcnt lgkmcnt(4)
    ds_read_b64_tr_b16 a[184:185], v5 offset:17408
    ds_read_b64_tr_b16 a[186:187], v5 offset:25600
    v_mfma_f32_16x16x32_bf16 v[96:99], a[160:163], v[84:87], v[96:99]
    v_add_f32 v16, v16, v57
    v_add_f32 v16, v16, v58
    v_mfma_f32_16x16x32_bf16 v[100:103], a[160:163], v[88:91], v[100:103]
    v_cvt_pk_bf16_f32 v81, v58, v59
    v_add_f32 v16, v16, v59
    v_mfma_f32_16x16x32_bf16 v[104:107], a[160:163], v[92:95], v[104:107]
    buffer_load_dword v45, v29, s[20:23], s39 offen
    v_mfma_f32_16x16x32_bf16 v[116:119], a[164:167], v[92:95], v[116:119]
    s_mov_b64 s[20:21], s[48:49]
    ds_read_b64_tr_b16 a[188:189], v6 offset:17408
    ds_read_b64_tr_b16 a[190:191], v6 offset:25600
    v_mfma_f32_16x16x32_bf16 v[112:115], a[164:167], v[88:91], v[112:115]
    s_mov_b32 s22, s54
    v_fma_f32 v60, v60, s29, v8
    v_fma_f32 v61, v61, s29, v8
    v_mfma_f32_16x16x32_bf16 v[108:111], a[164:167], v[84:87], v[108:111]
    ds_read_b64_tr_b16 a[160:161], v3 offset:18432
    v_fma_f32 v62, v62, s29, v8
    v_mfma_f32_16x16x32_bf16 v[120:123], a[168:171], v[84:87], v[120:123]
    ds_read_b64_tr_b16 a[162:163], v3 offset:26624
    v_fma_f32 v63, v63, s29, v8
    v_mfma_f32_16x16x32_bf16 v[124:127], a[168:171], v[88:91], v[124:127]
    v_exp_f32 v60, v60
    v_mfma_f32_16x16x32_bf16 v[128:131], a[168:171], v[92:95], v[128:131]
    v_exp_f32 v61, v61
    v_mfma_f32_16x16x32_bf16 v[140:143], a[172:175], v[92:95], v[140:143]
    ds_read_b64_tr_b16 a[164:165], v4 offset:18432
    ds_read_b64_tr_b16 a[166:167], v4 offset:26624
    v_mfma_f32_16x16x32_bf16 v[136:139], a[172:175], v[88:91], v[136:139]
    v_exp_f32 v62, v62
    v_mfma_f32_16x16x32_bf16 v[132:135], a[172:175], v[84:87], v[132:135]
    s_waitcnt lgkmcnt(4)
    v_exp_f32 v63, v63
    v_mfma_f32_16x16x32_bf16 v[144:147], a[176:179], v[84:87], v[144:147]
    buffer_load_dwordx4 v7, s[12:15], s26 offen offset:384 lds
    v_mfma_f32_16x16x32_bf16 v[148:151], a[176:179], v[88:91], v[148:151]
    s_add_u32 m0, s3, 0
    ds_read_b64_tr_b16 a[168:169], v5 offset:18432
    ds_read_b64_tr_b16 a[170:171], v5 offset:26624
    v_mfma_f32_16x16x32_bf16 v[152:155], a[176:179], v[92:95], v[152:155]
    ds_read_b64_tr_b16 a[172:173], v6 offset:18432
    v_add_f32 v14, v14, v60
    v_mfma_f32_16x16x32_bf16 v[164:167], a[180:183], v[92:95], v[164:167]
    ds_read_b64_tr_b16 a[174:175], v6 offset:26624
    v_cvt_pk_bf16_f32 v74, v60, v61
    v_mfma_f32_16x16x32_bf16 v[160:163], a[180:183], v[88:91], v[160:163]
    v_add_f32 v14, v14, v61
    v_add_f32 v14, v14, v62
    v_mfma_f32_16x16x32_bf16 v[156:159], a[180:183], v[84:87], v[156:159]
    ds_read_b64_tr_b16 a[176:177], v3 offset:19456
    v_cvt_pk_bf16_f32 v75, v62, v63
    v_mfma_f32_16x16x32_bf16 v[168:171], a[184:187], v[84:87], v[168:171]
    ds_read_b64_tr_b16 a[178:179], v3 offset:27648
    v_add_f32 v14, v14, v63
    v_mfma_f32_16x16x32_bf16 v[172:175], a[184:187], v[88:91], v[172:175]
    v_fma_f32 v64, v64, s29, v9
    v_fma_f32 v65, v65, s29, v9
    v_mfma_f32_16x16x32_bf16 v[176:179], a[184:187], v[92:95], v[176:179]
    ds_read_b64_tr_b16 a[180:181], v4 offset:19456
    v_fma_f32 v66, v66, s29, v9
    v_mfma_f32_16x16x32_bf16 v[188:191], a[188:191], v[92:95], v[188:191]
    ds_read_b64_tr_b16 a[182:183], v4 offset:27648
    v_fma_f32 v67, v67, s29, v9
    v_mfma_f32_16x16x32_bf16 v[184:187], a[188:191], v[88:91], v[184:187]
    buffer_load_dwordx4 v7, s[20:23], s41 offen nt lds
    v_mfma_f32_16x16x32_bf16 v[180:183], a[188:191], v[84:87], v[180:183]
    s_waitcnt lgkmcnt(4)
    v_exp_f32 v64, v64
    v_mfma_f32_16x16x32_bf16 v[192:195], a[160:163], v[84:87], v[192:195]
    s_add_u32 s26, s26, 16384
    ds_read_b64_tr_b16 a[184:185], v5 offset:19456
    ds_read_b64_tr_b16 a[186:187], v5 offset:27648
    v_mfma_f32_16x16x32_bf16 v[196:199], a[160:163], v[88:91], v[196:199]
    s_and_b32 s26, s26, 0x3ffff
    v_exp_f32 v65, v65
    v_mfma_f32_16x16x32_bf16 v[200:203], a[160:163], v[92:95], v[200:203]
    s_add_u32 s20, s52, s45
    ds_read_b64_tr_b16 a[188:189], v6 offset:19456
    ds_read_b64_tr_b16 a[190:191], v6 offset:27648
    v_mfma_f32_16x16x32_bf16 v[212:215], a[164:167], v[92:95], v[212:215]
    s_addc_u32 s21, s53, 0
    v_exp_f32 v66, v66
    v_mfma_f32_16x16x32_bf16 v[208:211], a[164:167], v[88:91], v[208:211]
    s_lshl_b32 s35, s28, 2
    v_exp_f32 v67, v67
    v_mfma_f32_16x16x32_bf16 v[204:207], a[164:167], v[84:87], v[204:207]
    s_add_u32 s35, s35, s27
    v_add_f32 v15, v15, v64
    v_cvt_pk_bf16_f32 v78, v64, v65
    v_mfma_f32_16x16x32_bf16 v[216:219], a[168:171], v[84:87], v[216:219]
    s_cmp_eq_u32 s35, 6
    v_add_f32 v15, v15, v65
    v_add_f32 v15, v15, v66
    v_mfma_f32_16x16x32_bf16 v[220:223], a[168:171], v[88:91], v[220:223]
    s_waitcnt vmcnt(19) lgkmcnt(0)
    v_cvt_pk_bf16_f32 v79, v66, v67
    v_add_f32 v15, v15, v67
    v_mfma_f32_16x16x32_bf16 v[224:227], a[168:171], v[92:95], v[224:227]
    s_barrier
    v_fma_f32 v68, v68, s29, v10
    v_fma_f32 v69, v69, s29, v10
    v_mfma_f32_16x16x32_bf16 v[236:239], a[172:175], v[92:95], v[236:239]
    ds_read_b128 a[96:99], v1 offset:49152
    v_fma_f32 v70, v70, s29, v10
    v_mfma_f32_16x16x32_bf16 v[232:235], a[172:175], v[88:91], v[232:235]
    ds_read_b128 a[100:103], v2 offset:49152
    v_fma_f32 v71, v71, s29, v10
    v_mfma_f32_16x16x32_bf16 v[228:231], a[172:175], v[84:87], v[228:231]
    ds_read_b128 a[104:107], v1 offset:50176
    v_mfma_f32_16x16x32_bf16 v[240:243], a[176:179], v[84:87], v[240:243]
    ds_read_b128 a[108:111], v2 offset:50176
    v_mfma_f32_16x16x32_bf16 v[244:247], a[176:179], v[88:91], v[244:247]
    ds_read_b128 a[112:115], v1 offset:51200
    v_mfma_f32_16x16x32_bf16 v[248:251], a[176:179], v[92:95], v[248:251]
    ds_read_b128 a[116:119], v2 offset:51200
    v_mfma_f32_16x16x32_bf16 a[196:199], a[180:183], v[92:95], a[196:199]
    ds_read_b128 a[120:123], v1 offset:52224
    v_mfma_f32_16x16x32_bf16 a[192:195], a[180:183], v[88:91], a[192:195]
    ds_read_b128 a[124:127], v2 offset:52224
    v_mfma_f32_16x16x32_bf16 v[252:255], a[180:183], v[84:87], v[252:255]
    v_exp_f32 v68, v68
    v_mfma_f32_16x16x32_bf16 a[200:203], a[184:187], v[84:87], a[200:203]
    v_exp_f32 v69, v69
    v_mfma_f32_16x16x32_bf16 a[204:207], a[184:187], v[88:91], a[204:207]
    v_exp_f32 v70, v70
    v_mfma_f32_16x16x32_bf16 a[208:211], a[184:187], v[92:95], a[208:211]
    v_exp_f32 v71, v71
    v_mfma_f32_16x16x32_bf16 a[220:223], a[188:191], v[92:95], a[220:223]
    v_add_f32 v16, v16, v68
    v_cvt_pk_bf16_f32 v82, v68, v69
    v_mfma_f32_16x16x32_bf16 a[216:219], a[188:191], v[88:91], a[216:219]
    v_add_f32 v16, v16, v69
    v_add_f32 v16, v16, v70
    v_mfma_f32_16x16x32_bf16 a[212:215], a[188:191], v[84:87], a[212:215]
    s_waitcnt lgkmcnt(0)
    v_cvt_pk_bf16_f32 v83, v70, v71
    v_add_f32 v16, v16, v71
    s_cbranch_scc1 L_tail1
    v_mfma_f32_16x16x32_bf16 v[48:51], a[96:99], a[0:3], 0
    s_mov_b32 m0, s72
    ds_read_b128 a[128:131], v1 offset:57344
    v_mfma_f32_16x16x32_bf16 v[48:51], a[100:103], a[4:7], v[48:51]
    buffer_load_dwordx4 v7, s[8:11], s25 offen lds
    v_mfma_f32_16x16x32_bf16 v[48:51], a[104:107], a[8:11], v[48:51]
    s_mov_b32 m0, s73
    ds_read_b128 a[132:135], v2 offset:57344
    v_mfma_f32_16x16x32_bf16 v[48:51], a[108:111], a[12:15], v[48:51]
    ds_read_b128 a[136:139], v1 offset:58368
    v_mfma_f32_16x16x32_bf16 v[48:51], a[112:115], a[16:19], v[48:51]
    buffer_load_dwordx4 v7, s[8:11], s25 offen offset:128 lds
    v_mfma_f32_16x16x32_bf16 v[48:51], a[116:119], a[20:23], v[48:51]
    s_mov_b32 m0, s74
    ds_read_b128 a[140:143], v2 offset:58368
    v_mfma_f32_16x16x32_bf16 v[48:51], a[120:123], a[24:27], v[48:51]
    ds_read_b128 a[144:147], v1 offset:59392
    v_mfma_f32_16x16x32_bf16 v[48:51], a[124:127], a[28:31], v[48:51]
    buffer_load_dwordx4 v7, s[8:11], s25 offen offset:256 lds
    v_mfma_f32_16x16x32_bf16 v[52:55], a[124:127], a[60:63], 0
    s_mov_b32 m0, s75
    ds_read_b128 a[148:151], v2 offset:59392
    v_mfma_f32_16x16x32_bf16 v[52:55], a[120:123], a[56:59], v[52:55]
    ds_read_b128 a[152:155], v1 offset:60416
    v_mfma_f32_16x16x32_bf16 v[52:55], a[116:119], a[52:55], v[52:55]
    buffer_load_dwordx4 v7, s[8:11], s25 offen offset:384 lds
    v_mfma_f32_16x16x32_bf16 v[52:55], a[112:115], a[48:51], v[52:55]
    s_mov_b32 m0, s84
    ds_read_b128 a[156:159], v2 offset:60416
    v_fma_f32 v48, v48, s29, v8
    v_mfma_f32_16x16x32_bf16 v[52:55], a[108:111], a[44:47], v[52:55]
    s_add_u32 s25, s25, 16384
    buffer_load_dwordx4 v7, s[12:15], s26 offen lds
    v_mfma_f32_16x16x32_bf16 v[52:55], a[104:107], a[40:43], v[52:55]
    s_mov_b32 m0, s85
    v_fma_f32 v49, v49, s29, v8
    v_fma_f32 v50, v50, s29, v8
    v_mfma_f32_16x16x32_bf16 v[52:55], a[100:103], a[36:39], v[52:55]
    s_and_b32 s25, s25, 0x3ffff
    v_fma_f32 v51, v51, s29, v8
    v_mfma_f32_16x16x32_bf16 v[52:55], a[96:99], a[32:35], v[52:55]
    s_mov_b32 s22, s34
    v_exp_f32 v48, v48
    v_mfma_f32_16x16x32_bf16 v[56:59], a[96:99], a[64:67], 0
    v_exp_f32 v49, v49
    v_mfma_f32_16x16x32_bf16 v[56:59], a[100:103], a[68:71], v[56:59]
    v_exp_f32 v50, v50
    v_mfma_f32_16x16x32_bf16 v[56:59], a[104:107], a[72:75], v[56:59]
    v_exp_f32 v51, v51
    v_mfma_f32_16x16x32_bf16 v[56:59], a[108:111], a[76:79], v[56:59]
    v_add_f32 v14, v14, v48
    v_cvt_pk_bf16_f32 v84, v48, v49
    v_mfma_f32_16x16x32_bf16 v[56:59], a[112:115], a[80:83], v[56:59]
    buffer_load_dwordx4 v7, s[12:15], s26 offen offset:128 lds
    v_mfma_f32_16x16x32_bf16 v[56:59], a[116:119], a[84:87], v[56:59]
    s_mov_b32 m0, s86
    v_add_f32 v14, v14, v49
    v_add_f32 v14, v14, v50
    v_mfma_f32_16x16x32_bf16 v[56:59], a[120:123], a[88:91], v[56:59]
    v_cvt_pk_bf16_f32 v85, v50, v51
    v_add_f32 v14, v14, v51
    v_mfma_f32_16x16x32_bf16 v[56:59], a[124:127], a[92:95], v[56:59]
    s_waitcnt lgkmcnt(0)
    v_fma_f32 v52, v52, s29, v9
    v_fma_f32 v53, v53, s29, v9
    v_mfma_f32_16x16x32_bf16 v[60:63], a[128:131], a[0:3], 0
    v_fma_f32 v54, v54, s29, v9
    v_fma_f32 v55, v55, s29, v9
    v_mfma_f32_16x16x32_bf16 v[60:63], a[132:135], a[4:7], v[60:63]
    v_exp_f32 v52, v52
    v_mfma_f32_16x16x32_bf16 v[60:63], a[136:139], a[8:11], v[60:63]
    v_exp_f32 v53, v53
    v_mfma_f32_16x16x32_bf16 v[60:63], a[140:143], a[12:15], v[60:63]
    v_exp_f32 v54, v54
    v_mfma_f32_16x16x32_bf16 v[60:63], a[144:147], a[16:19], v[60:63]
    v_exp_f32 v55, v55
    v_mfma_f32_16x16x32_bf16 v[60:63], a[148:151], a[20:23], v[60:63]
    ds_read_b64_tr_b16 a[160:161], v3 offset:32768
    ds_read_b64_tr_b16 a[162:163], v3 offset:40960
    v_mfma_f32_16x16x32_bf16 v[60:63], a[152:155], a[24:27], v[60:63]
    v_add_f32 v15, v15, v52
    v_cvt_pk_bf16_f32 v88, v52, v53
    v_mfma_f32_16x16x32_bf16 v[60:63], a[156:159], a[28:31], v[60:63]
    v_add_f32 v15, v15, v53
    v_add_f32 v15, v15, v54
    v_mfma_f32_16x16x32_bf16 v[64:67], a[156:159], a[60:63], 0
    ds_read_b64_tr_b16 a[164:165], v4 offset:32768
    ds_read_b64_tr_b16 a[166:167], v4 offset:40960
    v_mfma_f32_16x16x32_bf16 v[64:67], a[152:155], a[56:59], v[64:67]
    v_cvt_pk_bf16_f32 v89, v54, v55
    v_add_f32 v15, v15, v55
    v_mfma_f32_16x16x32_bf16 v[64:67], a[148:151], a[52:55], v[64:67]
    v_fma_f32 v56, v56, s29, v10
    v_fma_f32 v57, v57, s29, v10
    v_mfma_f32_16x16x32_bf16 v[64:67], a[144:147], a[48:51], v[64:67]
    ds_read_b64_tr_b16 a[168:169], v5 offset:32768
    ds_read_b64_tr_b16 a[170:171], v5 offset:40960
    v_mfma_f32_16x16x32_bf16 v[64:67], a[140:143], a[44:47], v[64:67]
    v_fma_f32 v58, v58, s29, v10
    v_fma_f32 v59, v59, s29, v10
    v_mfma_f32_16x16x32_bf16 v[64:67], a[136:139], a[40:43], v[64:67]
    v_exp_f32 v56, v56
    v_mfma_f32_16x16x32_bf16 v[64:67], a[132:135], a[36:39], v[64:67]
    ds_read_b64_tr_b16 a[172:173], v6 offset:32768
    ds_read_b64_tr_b16 a[174:175], v6 offset:40960
    v_mfma_f32_16x16x32_bf16 v[64:67], a[128:131], a[32:35], v[64:67]
    v_exp_f32 v57, v57
    v_mfma_f32_16x16x32_bf16 v[68:71], a[128:131], a[64:67], 0
    buffer_load_dwordx4 v7, s[12:15], s26 offen offset:256 lds
    v_mfma_f32_16x16x32_bf16 v[68:71], a[132:135], a[68:71], v[68:71]
    s_mov_b32 m0, s87
    ds_read_b64_tr_b16 a[176:177], v3 offset:33792
    ds_read_b64_tr_b16 a[178:179], v3 offset:41984
    v_mfma_f32_16x16x32_bf16 v[68:71], a[136:139], a[72:75], v[68:71]
    v_exp_f32 v58, v58
    v_mfma_f32_16x16x32_bf16 v[68:71], a[140:143], a[76:79], v[68:71]
    v_exp_f32 v59, v59
    v_mfma_f32_16x16x32_bf16 v[68:71], a[144:147], a[80:83], v[68:71]
    ds_read_b64_tr_b16 a[180:181], v4 offset:33792
    ds_read_b64_tr_b16 a[182:183], v4 offset:41984
    v_mfma_f32_16x16x32_bf16 v[68:71], a[148:151], a[84:87], v[68:71]
    v_add_f32 v16, v16, v56
    v_cvt_pk_bf16_f32 v92, v56, v57
    v_mfma_f32_16x16x32_bf16 v[68:71], a[152:155], a[88:91], v[68:71]
    v_add_f32 v16, v16, v57
    v_add_f32 v16, v16, v58
    v_mfma_f32_16x16x32_bf16 v[68:71], a[156:159], a[92:95], v[68:71]
    s_waitcnt lgkmcnt(4)
    ds_read_b64_tr_b16 a[184:185], v5 offset:33792
    ds_read_b64_tr_b16 a[186:187], v5 offset:41984
    v_mfma_f32_16x16x32_bf16 v[96:99], a[160:163], v[72:75], v[96:99]
    v_cvt_pk_bf16_f32 v93, v58, v59
    v_add_f32 v16, v16, v59
    v_mfma_f32_16x16x32_bf16 v[100:103], a[160:163], v[76:79], v[100:103]
    v_fma_f32 v60, v60, s29, v8
    v_fma_f32 v61, v61, s29, v8
    v_mfma_f32_16x16x32_bf16 v[104:107], a[160:163], v[80:83], v[104:107]
    buffer_load_dword v45, v29, s[20:23], s39 offen
    v_mfma_f32_16x16x32_bf16 v[116:119], a[164:167], v[80:83], v[116:119]
    s_mov_b64 s[20:21], s[48:49]
    ds_read_b64_tr_b16 a[188:189], v6 offset:33792
    ds_read_b64_tr_b16 a[190:191], v6 offset:41984
    v_mfma_f32_16x16x32_bf16 v[112:115], a[164:167], v[76:79], v[112:115]
    s_mov_b32 s22, s54
    v_fma_f32 v62, v62, s29, v8
    v_fma_f32 v63, v63, s29, v8
    v_mfma_f32_16x16x32_bf16 v[108:111], a[164:167], v[72:75], v[108:111]
    ds_read_b64_tr_b16 a[160:161], v3 offset:34816
    ds_read_b64_tr_b16 a[162:163], v3 offset:43008
    v_mfma_f32_16x16x32_bf16 v[120:123], a[168:171], v[72:75], v[120:123]
    v_exp_f32 v60, v60
    v_mfma_f32_16x16x32_bf16 v[124:127], a[168:171], v[76:79], v[124:127]
    v_exp_f32 v61, v61
    v_mfma_f32_16x16x32_bf16 v[128:131], a[168:171], v[80:83], v[128:131]
    ds_read_b64_tr_b16 a[164:165], v4 offset:34816
    ds_read_b64_tr_b16 a[166:167], v4 offset:43008
    v_mfma_f32_16x16x32_bf16 v[140:143], a[172:175], v[80:83], v[140:143]
    v_exp_f32 v62, v62
    v_mfma_f32_16x16x32_bf16 v[136:139], a[172:175], v[76:79], v[136:139]
    v_exp_f32 v63, v63
    v_mfma_f32_16x16x32_bf16 v[132:135], a[172:175], v[72:75], v[132:135]
    s_waitcnt lgkmcnt(5)
    ds_read_b64_tr_b16 a[168:169], v5 offset:34816
    ds_read_b64_tr_b16 a[170:171], v5 offset:43008
    v_mfma_f32_16x16x32_bf16 v[144:147], a[176:179], v[72:75], v[144:147]
    buffer_load_dwordx4 v7, s[12:15], s26 offen offset:384 lds
    v_mfma_f32_16x16x32_bf16 v[148:151], a[176:179], v[76:79], v[148:151]
    s_add_u32 m0, s3, 896
    v_add_f32 v14, v14, v60
    v_cvt_pk_bf16_f32 v86, v60, v61
    v_mfma_f32_16x16x32_bf16 v[152:155], a[176:179], v[80:83], v[152:155]
    ds_read_b64_tr_b16 a[172:173], v6 offset:34816
    v_add_f32 v14, v14, v61
    v_mfma_f32_16x16x32_bf16 v[164:167], a[180:183], v[80:83], v[164:167]
    ds_read_b64_tr_b16 a[174:175], v6 offset:43008
    v_add_f32 v14, v14, v62
    v_mfma_f32_16x16x32_bf16 v[160:163], a[180:183], v[76:79], v[160:163]
    v_cvt_pk_bf16_f32 v87, v62, v63
    v_add_f32 v14, v14, v63
    v_mfma_f32_16x16x32_bf16 v[156:159], a[180:183], v[72:75], v[156:159]
    ds_read_b64_tr_b16 a[176:177], v3 offset:35840
    v_fma_f32 v64, v64, s29, v9
    v_mfma_f32_16x16x32_bf16 v[168:171], a[184:187], v[72:75], v[168:171]
    ds_read_b64_tr_b16 a[178:179], v3 offset:44032
    v_fma_f32 v65, v65, s29, v9
    v_mfma_f32_16x16x32_bf16 v[172:175], a[184:187], v[76:79], v[172:175]
    v_fma_f32 v66, v66, s29, v9
    v_fma_f32 v67, v67, s29, v9
    v_mfma_f32_16x16x32_bf16 v[176:179], a[184:187], v[80:83], v[176:179]
    s_waitcnt lgkmcnt(4)
    buffer_load_dwordx4 v7, s[20:23], s41 offen offset:128 nt lds
    v_mfma_f32_16x16x32_bf16 v[188:191], a[188:191], v[80:83], v[188:191]
    s_add_u32 s26, s26, 16384
    ds_read_b64_tr_b16 a[180:181], v4 offset:35840
    ds_read_b64_tr_b16 a[182:183], v4 offset:44032
    v_mfma_f32_16x16x32_bf16 v[184:187], a[188:191], v[76:79], v[184:187]
    s_and_b32 s26, s26, 0x3ffff
    v_exp_f32 v64, v64
    v_mfma_f32_16x16x32_bf16 v[180:183], a[188:191], v[72:75], v[180:183]
    s_add_u32 s20, s50, s45
    ds_read_b64_tr_b16 a[184:185], v5 offset:35840
    ds_read_b64_tr_b16 a[186:187], v5 offset:44032
    v_mfma_f32_16x16x32_bf16 v[192:195], a[160:163], v[72:75], v[192:195]
    s_addc_u32 s21, s51, 0
    v_exp_f32 v65, v65
    v_mfma_f32_16x16x32_bf16 v[196:199], a[160:163], v[76:79], v[196:199]
    ds_read_b64_tr_b16 a[188:189], v6 offset:35840
    ds_read_b64_tr_b16 a[190:191], v6 offset:44032
    v_mfma_f32_16x16x32_bf16 v[200:203], a[160:163], v[80:83], v[200:203]
    v_exp_f32 v66, v66
    v_mfma_f32_16x16x32_bf16 v[212:215], a[164:167], v[80:83], v[212:215]
    v_exp_f32 v67, v67
    v_mfma_f32_16x16x32_bf16 v[208:211], a[164:167], v[76:79], v[208:211]
    v_add_f32 v15, v15, v64
    v_cvt_pk_bf16_f32 v90, v64, v65
    v_mfma_f32_16x16x32_bf16 v[204:207], a[164:167], v[72:75], v[204:207]
    v_add_f32 v15, v15, v65
    v_add_f32 v15, v15, v66
    v_mfma_f32_16x16x32_bf16 v[216:219], a[168:171], v[72:75], v[216:219]
    v_cvt_pk_bf16_f32 v91, v66, v67
    v_add_f32 v15, v15, v67
    v_mfma_f32_16x16x32_bf16 v[220:223], a[168:171], v[76:79], v[220:223]
    s_waitcnt vmcnt(21) lgkmcnt(0)
    v_fma_f32 v68, v68, s29, v10
    v_fma_f32 v69, v69, s29, v10
    v_mfma_f32_16x16x32_bf16 v[224:227], a[168:171], v[80:83], v[224:227]
    s_barrier
    v_fma_f32 v70, v70, s29, v10
    v_fma_f32 v71, v71, s29, v10
    v_mfma_f32_16x16x32_bf16 v[236:239], a[172:175], v[80:83], v[236:239]
    ds_read_b128 a[96:99], v1 offset:0
    v_mfma_f32_16x16x32_bf16 v[232:235], a[172:175], v[76:79], v[232:235]
    ds_read_b128 a[100:103], v2 offset:0
    v_mfma_f32_16x16x32_bf16 v[228:231], a[172:175], v[72:75], v[228:231]
    ds_read_b128 a[104:107], v1 offset:1024
    v_mfma_f32_16x16x32_bf16 v[240:243], a[176:179], v[72:75], v[240:243]
    ds_read_b128 a[108:111], v2 offset:1024
    v_mfma_f32_16x16x32_bf16 v[244:247], a[176:179], v[76:79], v[244:247]
    ds_read_b128 a[112:115], v1 offset:2048
    v_mfma_f32_16x16x32_bf16 v[248:251], a[176:179], v[80:83], v[248:251]
    ds_read_b128 a[116:119], v2 offset:2048
    v_mfma_f32_16x16x32_bf16 a[196:199], a[180:183], v[80:83], a[196:199]
    ds_read_b128 a[120:123], v1 offset:3072
    v_mfma_f32_16x16x32_bf16 a[192:195], a[180:183], v[76:79], a[192:195]
    ds_read_b128 a[124:127], v2 offset:3072
    v_mfma_f32_16x16x32_bf16 v[252:255], a[180:183], v[72:75], v[252:255]
    v_exp_f32 v68, v68
    v_mfma_f32_16x16x32_bf16 a[200:203], a[184:187], v[72:75], a[200:203]
    v_exp_f32 v69, v69
    v_mfma_f32_16x16x32_bf16 a[204:207], a[184:187], v[76:79], a[204:207]
    v_exp_f32 v70, v70
    v_mfma_f32_16x16x32_bf16 a[208:211], a[184:187], v[80:83], a[208:211]
    v_exp_f32 v71, v71
    v_mfma_f32_16x16x32_bf16 a[220:223], a[188:191], v[80:83], a[220:223]
    v_add_f32 v16, v16, v68
    v_cvt_pk_bf16_f32 v94, v68, v69
    v_mfma_f32_16x16x32_bf16 a[216:219], a[188:191], v[76:79], a[216:219]
    v_add_f32 v16, v16, v69
    v_add_f32 v16, v16, v70
    v_mfma_f32_16x16x32_bf16 a[212:215], a[188:191], v[72:75], a[212:215]
    s_waitcnt lgkmcnt(0)
    v_cvt_pk_bf16_f32 v95, v70, v71
    v_add_f32 v16, v16, v71
    v_mfma_f32_16x16x32_bf16 v[48:51], a[96:99], a[0:3], 0
    s_mov_b32 m0, s76
    ds_read_b128 a[128:131], v1 offset:8192
    v_mfma_f32_16x16x32_bf16 v[48:51], a[100:103], a[4:7], v[48:51]
    buffer_load_dwordx4 v7, s[8:11], s25 offen lds
    v_mfma_f32_16x16x32_bf16 v[48:51], a[104:107], a[8:11], v[48:51]
    s_mov_b32 m0, s77
    ds_read_b128 a[132:135], v2 offset:8192
    v_mfma_f32_16x16x32_bf16 v[48:51], a[108:111], a[12:15], v[48:51]
    ds_read_b128 a[136:139], v1 offset:9216
    v_mfma_f32_16x16x32_bf16 v[48:51], a[112:115], a[16:19], v[48:51]
    buffer_load_dwordx4 v7, s[8:11], s25 offen offset:128 lds
    v_mfma_f32_16x16x32_bf16 v[48:51], a[116:119], a[20:23], v[48:51]
    s_mov_b32 m0, s78
    ds_read_b128 a[140:143], v2 offset:9216
    v_mfma_f32_16x16x32_bf16 v[48:51], a[120:123], a[24:27], v[48:51]
    ds_read_b128 a[144:147], v1 offset:10240
    v_mfma_f32_16x16x32_bf16 v[48:51], a[124:127], a[28:31], v[48:51]
    buffer_load_dwordx4 v7, s[8:11], s25 offen offset:256 lds
    v_mfma_f32_16x16x32_bf16 v[52:55], a[124:127], a[60:63], 0
    s_mov_b32 m0, s79
    ds_read_b128 a[148:151], v2 offset:10240
    v_mfma_f32_16x16x32_bf16 v[52:55], a[120:123], a[56:59], v[52:55]
    ds_read_b128 a[152:155], v1 offset:11264
    v_mfma_f32_16x16x32_bf16 v[52:55], a[116:119], a[52:55], v[52:55]
    buffer_load_dwordx4 v7, s[8:11], s25 offen offset:384 lds
    v_mfma_f32_16x16x32_bf16 v[52:55], a[112:115], a[48:51], v[52:55]
    s_mov_b32 m0, s88
    ds_read_b128 a[156:159], v2 offset:11264
    v_fma_f32 v48, v48, s29, v8
    v_mfma_f32_16x16x32_bf16 v[52:55], a[108:111], a[44:47], v[52:55]
    s_add_u32 s25, s25, 16384
    buffer_load_dwordx4 v7, s[12:15], s26 offen lds
    v_mfma_f32_16x16x32_bf16 v[52:55], a[104:107], a[40:43], v[52:55]
    s_mov_b32 m0, s89
    v_fma_f32 v49, v49, s29, v8
    v_fma_f32 v50, v50, s29, v8
    v_mfma_f32_16x16x32_bf16 v[52:55], a[100:103], a[36:39], v[52:55]
    s_and_b32 s25, s25, 0x3ffff
    v_fma_f32 v51, v51, s29, v8
    v_mfma_f32_16x16x32_bf16 v[52:55], a[96:99], a[32:35], v[52:55]
    s_mov_b32 s22, s34
    v_exp_f32 v48, v48
    v_mfma_f32_16x16x32_bf16 v[56:59], a[96:99], a[64:67], 0
    v_exp_f32 v49, v49
    v_mfma_f32_16x16x32_bf16 v[56:59], a[100:103], a[68:71], v[56:59]
    v_exp_f32 v50, v50
    v_mfma_f32_16x16x32_bf16 v[56:59], a[104:107], a[72:75], v[56:59]
    v_exp_f32 v51, v51
    v_mfma_f32_16x16x32_bf16 v[56:59], a[108:111], a[76:79], v[56:59]
    v_add_f32 v14, v14, v48
    v_cvt_pk_bf16_f32 v72, v48, v49
    v_mfma_f32_16x16x32_bf16 v[56:59], a[112:115], a[80:83], v[56:59]
    buffer_load_dwordx4 v7, s[12:15], s26 offen offset:128 lds
    v_mfma_f32_16x16x32_bf16 v[56:59], a[116:119], a[84:87], v[56:59]
    s_mov_b32 m0, s90
    v_add_f32 v14, v14, v49
    v_add_f32 v14, v14, v50
    v_mfma_f32_16x16x32_bf16 v[56:59], a[120:123], a[88:91], v[56:59]
    v_cvt_pk_bf16_f32 v73, v50, v51
    v_add_f32 v14, v14, v51
    v_mfma_f32_16x16x32_bf16 v[56:59], a[124:127], a[92:95], v[56:59]
    s_waitcnt lgkmcnt(0)
    v_fma_f32 v52, v52, s29, v9
    v_fma_f32 v53, v53, s29, v9
    v_mfma_f32_16x16x32_bf16 v[60:63], a[128:131], a[0:3], 0
    v_fma_f32 v54, v54, s29, v9
    v_fma_f32 v55, v55, s29, v9
    v_mfma_f32_16x16x32_bf16 v[60:63], a[132:135], a[4:7], v[60:63]
    v_exp_f32 v52, v52
    v_mfma_f32_16x16x32_bf16 v[60:63], a[136:139], a[8:11], v[60:63]
    v_exp_f32 v53, v53
    v_mfma_f32_16x16x32_bf16 v[60:63], a[140:143], a[12:15], v[60:63]
    v_exp_f32 v54, v54
    v_mfma_f32_16x16x32_bf16 v[60:63], a[144:147], a[16:19], v[60:63]
    v_exp_f32 v55, v55
    v_mfma_f32_16x16x32_bf16 v[60:63], a[148:151], a[20:23], v[60:63]
    ds_read_b64_tr_b16 a[160:161], v3 offset:49152
    ds_read_b64_tr_b16 a[162:163], v3 offset:57344
    v_mfma_f32_16x16x32_bf16 v[60:63], a[152:155], a[24:27], v[60:63]
    v_add_f32 v15, v15, v52
    v_cvt_pk_bf16_f32 v76, v52, v53
    v_mfma_f32_16x16x32_bf16 v[60:63], a[156:159], a[28:31], v[60:63]
    v_add_f32 v15, v15, v53
    v_add_f32 v15, v15, v54
    v_mfma_f32_16x16x32_bf16 v[64:67], a[156:159], a[60:63], 0
    ds_read_b64_tr_b16 a[164:165], v4 offset:49152
    ds_read_b64_tr_b16 a[166:167], v4 offset:57344
    v_mfma_f32_16x16x32_bf16 v[64:67], a[152:155], a[56:59], v[64:67]
    v_cvt_pk_bf16_f32 v77, v54, v55
    v_add_f32 v15, v15, v55
    v_mfma_f32_16x16x32_bf16 v[64:67], a[148:151], a[52:55], v[64:67]
    v_fma_f32 v56, v56, s29, v10
    v_fma_f32 v57, v57, s29, v10
    v_mfma_f32_16x16x32_bf16 v[64:67], a[144:147], a[48:51], v[64:67]
    ds_read_b64_tr_b16 a[168:169], v5 offset:49152
    ds_read_b64_tr_b16 a[170:171], v5 offset:57344
    v_mfma_f32_16x16x32_bf16 v[64:67], a[140:143], a[44:47], v[64:67]
    v_fma_f32 v58, v58, s29, v10
    v_fma_f32 v59, v59, s29, v10
    v_mfma_f32_16x16x32_bf16 v[64:67], a[136:139], a[40:43], v[64:67]
    v_exp_f32 v56, v56
    v_mfma_f32_16x16x32_bf16 v[64:67], a[132:135], a[36:39], v[64:67]
    ds_read_b64_tr_b16 a[172:173], v6 offset:49152
    ds_read_b64_tr_b16 a[174:175], v6 offset:57344
    v_mfma_f32_16x16x32_bf16 v[64:67], a[128:131], a[32:35], v[64:67]
    v_exp_f32 v57, v57
    v_mfma_f32_16x16x32_bf16 v[68:71], a[128:131], a[64:67], 0
    buffer_load_dwordx4 v7, s[12:15], s26 offen offset:256 lds
    v_mfma_f32_16x16x32_bf16 v[68:71], a[132:135], a[68:71], v[68:71]
    s_mov_b32 m0, s91
    ds_read_b64_tr_b16 a[176:177], v3 offset:50176
    ds_read_b64_tr_b16 a[178:179], v3 offset:58368
    v_mfma_f32_16x16x32_bf16 v[68:71], a[136:139], a[72:75], v[68:71]
    v_exp_f32 v58, v58
    v_mfma_f32_16x16x32_bf16 v[68:71], a[140:143], a[76:79], v[68:71]
    v_exp_f32 v59, v59
    v_mfma_f32_16x16x32_bf16 v[68:71], a[144:147], a[80:83], v[68:71]
    ds_read_b64_tr_b16 a[180:181], v4 offset:50176
    ds_read_b64_tr_b16 a[182:183], v4 offset:58368
    v_mfma_f32_16x16x32_bf16 v[68:71], a[148:151], a[84:87], v[68:71]
    v_add_f32 v16, v16, v56
    v_cvt_pk_bf16_f32 v80, v56, v57
    v_mfma_f32_16x16x32_bf16 v[68:71], a[152:155], a[88:91], v[68:71]
    v_add_f32 v16, v16, v57
    v_add_f32 v16, v16, v58
    v_mfma_f32_16x16x32_bf16 v[68:71], a[156:159], a[92:95], v[68:71]
    s_waitcnt lgkmcnt(4)
    ds_read_b64_tr_b16 a[184:185], v5 offset:50176
    ds_read_b64_tr_b16 a[186:187], v5 offset:58368
    v_mfma_f32_16x16x32_bf16 v[96:99], a[160:163], v[84:87], v[96:99]
    v_cvt_pk_bf16_f32 v81, v58, v59
    v_add_f32 v16, v16, v59
    v_mfma_f32_16x16x32_bf16 v[100:103], a[160:163], v[88:91], v[100:103]
    v_fma_f32 v60, v60, s29, v8
    v_fma_f32 v61, v61, s29, v8
    v_mfma_f32_16x16x32_bf16 v[104:107], a[160:163], v[92:95], v[104:107]
    buffer_load_dword v45, v29, s[20:23], s39 offen offset:2048
    v_mfma_f32_16x16x32_bf16 v[116:119], a[164:167], v[92:95], v[116:119]
    s_mov_b64 s[20:21], s[48:49]
    ds_read_b64_tr_b16 a[188:189], v6 offset:50176
    ds_read_b64_tr_b16 a[190:191], v6 offset:58368
    v_mfma_f32_16x16x32_bf16 v[112:115], a[164:167], v[88:91], v[112:115]
    s_mov_b32 s22, s54
    v_fma_f32 v62, v62, s29, v8
    v_fma_f32 v63, v63, s29, v8
    v_mfma_f32_16x16x32_bf16 v[108:111], a[164:167], v[84:87], v[108:111]
    ds_read_b64_tr_b16 a[160:161], v3 offset:51200
    ds_read_b64_tr_b16 a[162:163], v3 offset:59392
    v_mfma_f32_16x16x32_bf16 v[120:123], a[168:171], v[84:87], v[120:123]
    v_exp_f32 v60, v60
    v_mfma_f32_16x16x32_bf16 v[124:127], a[168:171], v[88:91], v[124:127]
    v_exp_f32 v61, v61
    v_mfma_f32_16x16x32_bf16 v[128:131], a[168:171], v[92:95], v[128:131]
    ds_read_b64_tr_b16 a[164:165], v4 offset:51200
    ds_read_b64_tr_b16 a[166:167], v4 offset:59392
    v_mfma_f32_16x16x32_bf16 v[140:143], a[172:175], v[92:95], v[140:143]
    v_exp_f32 v62, v62
    v_mfma_f32_16x16x32_bf16 v[136:139], a[172:175], v[88:91], v[136:139]
    v_exp_f32 v63, v63
    v_mfma_f32_16x16x32_bf16 v[132:135], a[172:175], v[84:87], v[132:135]
    s_waitcnt lgkmcnt(5)
    ds_read_b64_tr_b16 a[168:169], v5 offset:51200
    ds_read_b64_tr_b16 a[170:171], v5 offset:59392
    v_mfma_f32_16x16x32_bf16 v[144:147], a[176:179], v[84:87], v[144:147]
    buffer_load_dwordx4 v7, s[12:15], s26 offen offset:384 lds
    v_mfma_f32_16x16x32_bf16 v[148:151], a[176:179], v[88:91], v[148:151]
    s_add_u32 m0, s3, 1792
    v_add_f32 v14, v14, v60
    v_cvt_pk_bf16_f32 v74, v60, v61
    v_mfma_f32_16x16x32_bf16 v[152:155], a[176:179], v[92:95], v[152:155]
    ds_read_b64_tr_b16 a[172:173], v6 offset:51200
    v_add_f32 v14, v14, v61
    v_mfma_f32_16x16x32_bf16 v[164:167], a[180:183], v[92:95], v[164:167]
    ds_read_b64_tr_b16 a[174:175], v6 offset:59392
    v_add_f32 v14, v14, v62
    v_mfma_f32_16x16x32_bf16 v[160:163], a[180:183], v[88:91], v[160:163]
    v_cvt_pk_bf16_f32 v75, v62, v63
    v_add_f32 v14, v14, v63
    v_mfma_f32_16x16x32_bf16 v[156:159], a[180:183], v[84:87], v[156:159]
    ds_read_b64_tr_b16 a[176:177], v3 offset:52224
    v_fma_f32 v64, v64, s29, v9
    v_mfma_f32_16x16x32_bf16 v[168:171], a[184:187], v[84:87], v[168:171]
    ds_read_b64_tr_b16 a[178:179], v3 offset:60416
    v_fma_f32 v65, v65, s29, v9
    v_mfma_f32_16x16x32_bf16 v[172:175], a[184:187], v[88:91], v[172:175]
    v_fma_f32 v66, v66, s29, v9
    v_fma_f32 v67, v67, s29, v9
    v_mfma_f32_16x16x32_bf16 v[176:179], a[184:187], v[92:95], v[176:179]
    s_waitcnt lgkmcnt(4)
    buffer_load_dwordx4 v7, s[20:23], s41 offen offset:256 nt lds
    v_mfma_f32_16x16x32_bf16 v[188:191], a[188:191], v[92:95], v[188:191]
    s_add_u32 s26, s26, 16384
    ds_read_b64_tr_b16 a[180:181], v4 offset:52224
    ds_read_b64_tr_b16 a[182:183], v4 offset:60416
    v_mfma_f32_16x16x32_bf16 v[184:187], a[188:191], v[88:91], v[184:187]
    s_and_b32 s26, s26, 0x3ffff
    v_exp_f32 v64, v64
    v_mfma_f32_16x16x32_bf16 v[180:183], a[188:191], v[84:87], v[180:183]
    s_add_u32 s20, s52, s45
    ds_read_b64_tr_b16 a[184:185], v5 offset:52224
    ds_read_b64_tr_b16 a[186:187], v5 offset:60416
    v_mfma_f32_16x16x32_bf16 v[192:195], a[160:163], v[84:87], v[192:195]
    s_addc_u32 s21, s53, 0
    v_exp_f32 v65, v65
    v_mfma_f32_16x16x32_bf16 v[196:199], a[160:163], v[88:91], v[196:199]
    s_add_u32 s3, s3, 4096
    ds_read_b64_tr_b16 a[188:189], v6 offset:52224
    ds_read_b64_tr_b16 a[190:191], v6 offset:60416
    v_mfma_f32_16x16x32_bf16 v[200:203], a[160:163], v[92:95], v[200:203]
    s_add_u32 s41, s41, 4096
    v_exp_f32 v66, v66
    v_mfma_f32_16x16x32_bf16 v[212:215], a[164:167], v[92:95], v[212:215]
    s_add_u32 s39, s39, 4096
    v_exp_f32 v67, v67
    v_mfma_f32_16x16x32_bf16 v[208:211], a[164:167], v[88:91], v[208:211]
    s_or_b32 s35, s27, s28
    v_add_f32 v15, v15, v64
    v_cvt_pk_bf16_f32 v78, v64, v65
    v_mfma_f32_16x16x32_bf16 v[204:207], a[164:167], v[84:87], v[204:207]
    s_cselect_b32 s3, s3, s38
    v_add_f32 v15, v15, v65
    v_add_f32 v15, v15, v66
    v_mfma_f32_16x16x32_bf16 v[216:219], a[168:171], v[84:87], v[216:219]
    s_cselect_b32 s41, s41, s32
    v_cvt_pk_bf16_f32 v79, v66, v67
    v_add_f32 v15, v15, v67
    v_mfma_f32_16x16x32_bf16 v[220:223], a[168:171], v[88:91], v[220:223]
    s_waitcnt vmcnt(21) lgkmcnt(0)
    v_fma_f32 v68, v68, s29, v10
    v_fma_f32 v69, v69, s29, v10
    v_mfma_f32_16x16x32_bf16 v[224:227], a[168:171], v[92:95], v[224:227]
    s_barrier
    v_fma_f32 v70, v70, s29, v10
    v_fma_f32 v71, v71, s29, v10
    v_mfma_f32_16x16x32_bf16 v[236:239], a[172:175], v[92:95], v[236:239]
    s_cselect_b32 s39, s39, 0
    ds_read_b128 a[96:99], v1 offset:16384
    v_mfma_f32_16x16x32_bf16 v[232:235], a[172:175], v[88:91], v[232:235]
    s_cselect_b32 s54, s54, 50331648
    ds_read_b128 a[100:103], v2 offset:16384
    v_mfma_f32_16x16x32_bf16 v[228:231], a[172:175], v[84:87], v[228:231]
    s_cselect_b32 s34, s34, 262144
    ds_read_b128 a[104:107], v1 offset:17408
    v_mfma_f32_16x16x32_bf16 v[240:243], a[176:179], v[84:87], v[240:243]
    s_cmp_eq_u32 s27, 2
    ds_read_b128 a[108:111], v2 offset:17408
    v_mfma_f32_16x16x32_bf16 v[244:247], a[176:179], v[88:91], v[244:247]
    s_cselect_b32 s35, 16777216, 0
    ds_read_b128 a[112:115], v1 offset:18432
    v_mfma_f32_16x16x32_bf16 v[248:251], a[176:179], v[92:95], v[248:251]
    s_add_u32 s8, s8, s35
    ds_read_b128 a[116:119], v2 offset:18432
    v_mfma_f32_16x16x32_bf16 a[196:199], a[180:183], v[92:95], a[196:199]
    s_addc_u32 s9, s9, 0
    ds_read_b128 a[120:123], v1 offset:19456
    v_mfma_f32_16x16x32_bf16 a[192:195], a[180:183], v[88:91], a[192:195]
    s_cmp_eq_u32 s27, 2
    ds_read_b128 a[124:127], v2 offset:19456
    v_mfma_f32_16x16x32_bf16 v[252:255], a[180:183], v[84:87], v[252:255]
    v_exp_f32 v68, v68
    v_mfma_f32_16x16x32_bf16 a[200:203], a[184:187], v[84:87], a[200:203]
    v_exp_f32 v69, v69
    v_mfma_f32_16x16x32_bf16 a[204:207], a[184:187], v[88:91], a[204:207]
    v_exp_f32 v70, v70
    v_mfma_f32_16x16x32_bf16 a[208:211], a[184:187], v[92:95], a[208:211]
    v_exp_f32 v71, v71
    v_mfma_f32_16x16x32_bf16 a[220:223], a[188:191], v[92:95], a[220:223]
    v_add_f32 v16, v16, v68
    v_cvt_pk_bf16_f32 v82, v68, v69
    v_mfma_f32_16x16x32_bf16 a[216:219], a[188:191], v[88:91], a[216:219]
    v_add_f32 v16, v16, v69
    v_add_f32 v16, v16, v70
    v_mfma_f32_16x16x32_bf16 a[212:215], a[188:191], v[84:87], a[212:215]
    s_waitcnt lgkmcnt(0)
    v_cvt_pk_bf16_f32 v83, v70, v71
    v_add_f32 v16, v16, v71
    s_cbranch_scc1 L_tail
    v_mfma_f32_16x16x32_bf16 v[48:51], a[96:99], a[0:3], 0
    s_mov_b32 m0, s64
    ds_read_b128 a[128:131], v1 offset:24576
    v_mfma_f32_16x16x32_bf16 v[48:51], a[100:103], a[4:7], v[48:51]
    buffer_load_dwordx4 v7, s[8:11], s25 offen lds
    v_mfma_f32_16x16x32_bf16 v[48:51], a[104:107], a[8:11], v[48:51]
    s_mov_b32 m0, s65
    ds_read_b128 a[132:135], v2 offset:24576
    v_mfma_f32_16x16x32_bf16 v[48:51], a[108:111], a[12:15], v[48:51]
    ds_read_b128 a[136:139], v1 offset:25600
    v_mfma_f32_16x16x32_bf16 v[48:51], a[112:115], a[16:19], v[48:51]
    buffer_load_dwordx4 v7, s[8:11], s25 offen offset:128 lds
    v_mfma_f32_16x16x32_bf16 v[48:51], a[116:119], a[20:23], v[48:51]
    s_mov_b32 m0, s66
    ds_read_b128 a[140:143], v2 offset:25600
    v_mfma_f32_16x16x32_bf16 v[48:51], a[120:123], a[24:27], v[48:51]
    ds_read_b128 a[144:147], v1 offset:26624
    v_mfma_f32_16x16x32_bf16 v[48:51], a[124:127], a[28:31], v[48:51]
    buffer_load_dwordx4 v7, s[8:11], s25 offen offset:256 lds
    v_mfma_f32_16x16x32_bf16 v[52:55], a[124:127], a[60:63], 0
    s_mov_b32 m0, s67
    ds_read_b128 a[148:151], v2 offset:26624
    v_mfma_f32_16x16x32_bf16 v[52:55], a[120:123], a[56:59], v[52:55]
    ds_read_b128 a[152:155], v1 offset:27648
    v_mfma_f32_16x16x32_bf16 v[52:55], a[116:119], a[52:55], v[52:55]
    buffer_load_dwordx4 v7, s[8:11], s25 offen offset:384 lds
    v_mfma_f32_16x16x32_bf16 v[52:55], a[112:115], a[48:51], v[52:55]
    s_mov_b32 m0, s92
    ds_read_b128 a[156:159], v2 offset:27648
    v_fma_f32 v48, v48, s29, v8
    v_mfma_f32_16x16x32_bf16 v[52:55], a[108:111], a[44:47], v[52:55]
    s_add_u32 s25, s25, 16384
    buffer_load_dwordx4 v7, s[12:15], s26 offen lds
    v_mfma_f32_16x16x32_bf16 v[52:55], a[104:107], a[40:43], v[52:55]
    s_mov_b32 m0, s93
    v_fma_f32 v49, v49, s29, v8
    v_fma_f32 v50, v50, s29, v8
    v_mfma_f32_16x16x32_bf16 v[52:55], a[100:103], a[36:39], v[52:55]
    s_and_b32 s25, s25, 0x3ffff
    v_fma_f32 v51, v51, s29, v8
    v_mfma_f32_16x16x32_bf16 v[52:55], a[96:99], a[32:35], v[52:55]
    s_mov_b32 s22, s34
    v_exp_f32 v48, v48
    v_mfma_f32_16x16x32_bf16 v[56:59], a[96:99], a[64:67], 0
    v_exp_f32 v49, v49
    v_mfma_f32_16x16x32_bf16 v[56:59], a[100:103], a[68:71], v[56:59]
    v_exp_f32 v50, v50
    v_mfma_f32_16x16x32_bf16 v[56:59], a[104:107], a[72:75], v[56:59]
    v_exp_f32 v51, v51
    v_mfma_f32_16x16x32_bf16 v[56:59], a[108:111], a[76:79], v[56:59]
    v_add_f32 v14, v14, v48
    v_cvt_pk_bf16_f32 v84, v48, v49
    v_mfma_f32_16x16x32_bf16 v[56:59], a[112:115], a[80:83], v[56:59]
    buffer_load_dwordx4 v7, s[12:15], s26 offen offset:128 lds
    v_mfma_f32_16x16x32_bf16 v[56:59], a[116:119], a[84:87], v[56:59]
    s_mov_b32 m0, s94
    v_add_f32 v14, v14, v49
    v_add_f32 v14, v14, v50
    v_mfma_f32_16x16x32_bf16 v[56:59], a[120:123], a[88:91], v[56:59]
    v_cvt_pk_bf16_f32 v85, v50, v51
    v_add_f32 v14, v14, v51
    v_mfma_f32_16x16x32_bf16 v[56:59], a[124:127], a[92:95], v[56:59]
    s_waitcnt lgkmcnt(0)
    v_fma_f32 v52, v52, s29, v9
    v_fma_f32 v53, v53, s29, v9
    v_mfma_f32_16x16x32_bf16 v[60:63], a[128:131], a[0:3], 0
    v_fma_f32 v54, v54, s29, v9
    v_fma_f32 v55, v55, s29, v9
    v_mfma_f32_16x16x32_bf16 v[60:63], a[132:135], a[4:7], v[60:63]
    v_exp_f32 v52, v52
    v_mfma_f32_16x16x32_bf16 v[60:63], a[136:139], a[8:11], v[60:63]
    v_exp_f32 v53, v53
    v_mfma_f32_16x16x32_bf16 v[60:63], a[140:143], a[12:15], v[60:63]
    v_exp_f32 v54, v54
    v_mfma_f32_16x16x32_bf16 v[60:63], a[144:147], a[16:19], v[60:63]
    v_exp_f32 v55, v55
    v_mfma_f32_16x16x32_bf16 v[60:63], a[148:151], a[20:23], v[60:63]
    ds_read_b64_tr_b16 a[160:161], v3 offset:0
    ds_read_b64_tr_b16 a[162:163], v3 offset:8192
    v_mfma_f32_16x16x32_bf16 v[60:63], a[152:155], a[24:27], v[60:63]
    v_add_f32 v15, v15, v52
    v_cvt_pk_bf16_f32 v88, v52, v53
    v_mfma_f32_16x16x32_bf16 v[60:63], a[156:159], a[28:31], v[60:63]
    v_add_f32 v15, v15, v53
    v_add_f32 v15, v15, v54
    v_mfma_f32_16x16x32_bf16 v[64:67], a[156:159], a[60:63], 0
    ds_read_b64_tr_b16 a[164:165], v4 offset:0
    ds_read_b64_tr_b16 a[166:167], v4 offset:8192
    v_mfma_f32_16x16x32_bf16 v[64:67], a[152:155], a[56:59], v[64:67]
    v_cvt_pk_bf16_f32 v89, v54, v55
    v_add_f32 v15, v15, v55
    v_mfma_f32_16x16x32_bf16 v[64:67], a[148:151], a[52:55], v[64:67]
    v_fma_f32 v56, v56, s29, v10
    v_fma_f32 v57, v57, s29, v10
    v_mfma_f32_16x16x32_bf16 v[64:67], a[144:147], a[48:51], v[64:67]
    ds_read_b64_tr_b16 a[168:169], v5 offset:0
    ds_read_b64_tr_b16 a[170:171], v5 offset:8192
    v_mfma_f32_16x16x32_bf16 v[64:67], a[140:143], a[44:47], v[64:67]
    v_fma_f32 v58, v58, s29, v10
    v_fma_f32 v59, v59, s29, v10
    v_mfma_f32_16x16x32_bf16 v[64:67], a[136:139], a[40:43], v[64:67]
    v_exp_f32 v56, v56
    v_mfma_f32_16x16x32_bf16 v[64:67], a[132:135], a[36:39], v[64:67]
    ds_read_b64_tr_b16 a[172:173], v6 offset:0
    ds_read_b64_tr_b16 a[174:175], v6 offset:8192
    v_mfma_f32_16x16x32_bf16 v[64:67], a[128:131], a[32:35], v[64:67]
    v_exp_f32 v57, v57
    v_mfma_f32_16x16x32_bf16 v[68:71], a[128:131], a[64:67], 0
    buffer_load_dwordx4 v7, s[12:15], s26 offen offset:256 lds
    v_mfma_f32_16x16x32_bf16 v[68:71], a[132:135], a[68:71], v[68:71]
    s_mov_b32 m0, s95
    ds_read_b64_tr_b16 a[176:177], v3 offset:1024
    ds_read_b64_tr_b16 a[178:179], v3 offset:9216
    v_mfma_f32_16x16x32_bf16 v[68:71], a[136:139], a[72:75], v[68:71]
    v_exp_f32 v58, v58
    v_mfma_f32_16x16x32_bf16 v[68:71], a[140:143], a[76:79], v[68:71]
    v_exp_f32 v59, v59
    v_mfma_f32_16x16x32_bf16 v[68:71], a[144:147], a[80:83], v[68:71]
    ds_read_b64_tr_b16 a[180:181], v4 offset:1024
    ds_read_b64_tr_b16 a[182:183], v4 offset:9216
    v_mfma_f32_16x16x32_bf16 v[68:71], a[148:151], a[84:87], v[68:71]
    v_add_f32 v16, v16, v56
    v_cvt_pk_bf16_f32 v92, v56, v57
    v_mfma_f32_16x16x32_bf16 v[68:71], a[152:155], a[88:91], v[68:71]
    v_add_f32 v16, v16, v57
    v_add_f32 v16, v16, v58
    v_mfma_f32_16x16x32_bf16 v[68:71], a[156:159], a[92:95], v[68:71]
    s_waitcnt lgkmcnt(4)
    ds_read_b64_tr_b16 a[184:185], v5 offset:1024
    ds_read_b64_tr_b16 a[186:187], v5 offset:9216
    v_mfma_f32_16x16x32_bf16 v[96:99], a[160:163], v[72:75], v[96:99]
    v_cvt_pk_bf16_f32 v93, v58, v59
    v_add_f32 v16, v16, v59
    v_mfma_f32_16x16x32_bf16 v[100:103], a[160:163], v[76:79], v[100:103]
    v_fma_f32 v60, v60, s29, v8
    v_fma_f32 v61, v61, s29, v8
    v_mfma_f32_16x16x32_bf16 v[104:107], a[160:163], v[80:83], v[104:107]
    buffer_load_dword v45, v29, s[20:23], s39 offen offset:2048
    v_mfma_f32_16x16x32_bf16 v[116:119], a[164:167], v[80:83], v[116:119]
    s_mov_b64 s[20:21], s[48:49]
    ds_read_b64_tr_b16 a[188:189], v6 offset:1024
    ds_read_b64_tr_b16 a[190:191], v6 offset:9216
    v_mfma_f32_16x16x32_bf16 v[112:115], a[164:167], v[76:79], v[112:115]
    s_mov_b32 s22, s54
    v_fma_f32 v62, v62, s29, v8
    v_fma_f32 v63, v63, s29, v8
    v_mfma_f32_16x16x32_bf16 v[108:111], a[164:167], v[72:75], v[108:111]
    ds_read_b64_tr_b16 a[160:161], v3 offset:2048
    ds_read_b64_tr_b16 a[162:163], v3 offset:10240
    v_mfma_f32_16x16x32_bf16 v[120:123], a[168:171], v[72:75], v[120:123]
    v_exp_f32 v60, v60
    v_mfma_f32_16x16x32_bf16 v[124:127], a[168:171], v[76:79], v[124:127]
    v_exp_f32 v61, v61
    v_mfma_f32_16x16x32_bf16 v[128:131], a[168:171], v[80:83], v[128:131]
    ds_read_b64_tr_b16 a[164:165], v4 offset:2048
    ds_read_b64_tr_b16 a[166:167], v4 offset:10240
    v_mfma_f32_16x16x32_bf16 v[140:143], a[172:175], v[80:83], v[140:143]
    v_exp_f32 v62, v62
    v_mfma_f32_16x16x32_bf16 v[136:139], a[172:175], v[76:79], v[136:139]
    v_exp_f32 v63, v63
    v_mfma_f32_16x16x32_bf16 v[132:135], a[172:175], v[72:75], v[132:135]
    s_waitcnt lgkmcnt(5)
    ds_read_b64_tr_b16 a[168:169], v5 offset:2048
    ds_read_b64_tr_b16 a[170:171], v5 offset:10240
    v_mfma_f32_16x16x32_bf16 v[144:147], a[176:179], v[72:75], v[144:147]
    buffer_load_dwordx4 v7, s[12:15], s26 offen offset:384 lds
    v_mfma_f32_16x16x32_bf16 v[148:151], a[176:179], v[76:79], v[148:151]
    s_add_u32 m0, s3, 2688
    v_add_f32 v14, v14, v60
    v_cvt_pk_bf16_f32 v86, v60, v61
    v_mfma_f32_16x16x32_bf16 v[152:155], a[176:179], v[80:83], v[152:155]
    ds_read_b64_tr_b16 a[172:173], v6 offset:2048
    v_add_f32 v14, v14, v61
    v_mfma_f32_16x16x32_bf16 v[164:167], a[180:183], v[80:83], v[164:167]
    ds_read_b64_tr_b16 a[174:175], v6 offset:10240
    v_add_f32 v14, v14, v62
    v_mfma_f32_16x16x32_bf16 v[160:163], a[180:183], v[76:79], v[160:163]
    v_cvt_pk_bf16_f32 v87, v62, v63
    v_add_f32 v14, v14, v63
    v_mfma_f32_16x16x32_bf16 v[156:159], a[180:183], v[72:75], v[156:159]
    ds_read_b64_tr_b16 a[176:177], v3 offset:3072
    v_fma_f32 v64, v64, s29, v9
    v_mfma_f32_16x16x32_bf16 v[168:171], a[184:187], v[72:75], v[168:171]
    ds_read_b64_tr_b16 a[178:179], v3 offset:11264
    v_fma_f32 v65, v65, s29, v9
    v_mfma_f32_16x16x32_bf16 v[172:175], a[184:187], v[76:79], v[172:175]
    v_fma_f32 v66, v66, s29, v9
    v_fma_f32 v67, v67, s29, v9
    v_mfma_f32_16x16x32_bf16 v[176:179], a[184:187], v[80:83], v[176:179]
    s_waitcnt lgkmcnt(4)
    buffer_load_dwordx4 v7, s[20:23], s41 offen offset:384 nt lds
    v_mfma_f32_16x16x32_bf16 v[188:191], a[188:191], v[80:83], v[188:191]
    s_add_u32 s26, s26, 16384
    ds_read_b64_tr_b16 a[180:181], v4 offset:3072
    ds_read_b64_tr_b16 a[182:183], v4 offset:11264
    v_mfma_f32_16x16x32_bf16 v[184:187], a[188:191], v[76:79], v[184:187]
    s_and_b32 s26, s26, 0x3ffff
    v_exp_f32 v64, v64
    v_mfma_f32_16x16x32_bf16 v[180:183], a[188:191], v[72:75], v[180:183]
    s_add_u32 s20, s50, s45
    ds_read_b64_tr_b16 a[184:185], v5 offset:3072
    ds_read_b64_tr_b16 a[186:187], v5 offset:11264
    v_mfma_f32_16x16x32_bf16 v[192:195], a[160:163], v[72:75], v[192:195]
    s_addc_u32 s21, s51, 0
    v_exp_f32 v65, v65
    v_mfma_f32_16x16x32_bf16 v[196:199], a[160:163], v[76:79], v[196:199]
    s_add_u32 s27, s27, 1
    ds_read_b64_tr_b16 a[188:189], v6 offset:3072
    ds_read_b64_tr_b16 a[190:191], v6 offset:11264
    v_mfma_f32_16x16x32_bf16 v[200:203], a[160:163], v[80:83], v[200:203]
    v_exp_f32 v66, v66
    v_mfma_f32_16x16x32_bf16 v[212:215], a[164:167], v[80:83], v[212:215]
    v_exp_f32 v67, v67
    v_mfma_f32_16x16x32_bf16 v[208:211], a[164:167], v[76:79], v[208:211]
    v_add_f32 v15, v15, v64
    v_cvt_pk_bf16_f32 v90, v64, v65
    v_mfma_f32_16x16x32_bf16 v[204:207], a[164:167], v[72:75], v[204:207]
    v_add_f32 v15, v15, v65
    v_add_f32 v15, v15, v66
    v_mfma_f32_16x16x32_bf16 v[216:219], a[168:171], v[72:75], v[216:219]
    v_cvt_pk_bf16_f32 v91, v66, v67
    v_add_f32 v15, v15, v67
    v_mfma_f32_16x16x32_bf16 v[220:223], a[168:171], v[76:79], v[220:223]
    s_waitcnt vmcnt(21) lgkmcnt(0)
    v_fma_f32 v68, v68, s29, v10
    v_fma_f32 v69, v69, s29, v10
    v_mfma_f32_16x16x32_bf16 v[224:227], a[168:171], v[80:83], v[224:227]
    s_barrier
    v_fma_f32 v70, v70, s29, v10
    v_fma_f32 v71, v71, s29, v10
    v_mfma_f32_16x16x32_bf16 v[236:239], a[172:175], v[80:83], v[236:239]
    ds_read_b128 a[96:99], v1 offset:32768
    v_mfma_f32_16x16x32_bf16 v[232:235], a[172:175], v[76:79], v[232:235]
    ds_read_b128 a[100:103], v2 offset:32768
    v_mfma_f32_16x16x32_bf16 v[228:231], a[172:175], v[72:75], v[228:231]
    ds_read_b128 a[104:107], v1 offset:33792
    v_mfma_f32_16x16x32_bf16 v[240:243], a[176:179], v[72:75], v[240:243]
    ds_read_b128 a[108:111], v2 offset:33792
    v_mfma_f32_16x16x32_bf16 v[244:247], a[176:179], v[76:79], v[244:247]
    ds_read_b128 a[112:115], v1 offset:34816
    v_mfma_f32_16x16x32_bf16 v[248:251], a[176:179], v[80:83], v[248:251]
    ds_read_b128 a[116:119], v2 offset:34816
    v_mfma_f32_16x16x32_bf16 a[196:199], a[180:183], v[80:83], a[196:199]
    ds_read_b128 a[120:123], v1 offset:35840
    v_mfma_f32_16x16x32_bf16 a[192:195], a[180:183], v[76:79], a[192:195]
    ds_read_b128 a[124:127], v2 offset:35840
    v_mfma_f32_16x16x32_bf16 v[252:255], a[180:183], v[72:75], v[252:255]
    v_exp_f32 v68, v68
    v_mfma_f32_16x16x32_bf16 a[200:203], a[184:187], v[72:75], a[200:203]
    v_exp_f32 v69, v69
    v_mfma_f32_16x16x32_bf16 a[204:207], a[184:187], v[76:79], a[204:207]
    v_exp_f32 v70, v70
    v_mfma_f32_16x16x32_bf16 a[208:211], a[184:187], v[80:83], a[208:211]
    v_exp_f32 v71, v71
    v_mfma_f32_16x16x32_bf16 a[220:223], a[188:191], v[80:83], a[220:223]
    v_add_f32 v16, v16, v68
    v_cvt_pk_bf16_f32 v94, v68, v69
    v_mfma_f32_16x16x32_bf16 a[216:219], a[188:191], v[76:79], a[216:219]
    v_add_f32 v16, v16, v69
    v_add_f32 v16, v16, v70
    v_mfma_f32_16x16x32_bf16 a[212:215], a[188:191], v[72:75], a[212:215]
    s_waitcnt lgkmcnt(0)
    v_cvt_pk_bf16_f32 v95, v70, v71
    v_add_f32 v16, v16, v71
    s_branch L_u1
.fill 0, 4, 0xbf800000
L_tail:
    v_mfma_f32_16x16x32_bf16 v[48:51], a[96:99], a[0:3], 0
    s_mov_b32 m0, s92
    ds_read_b128 a[128:131], v1 offset:24576
    v_mov_b32 v39, 0x3f803f80
    v_mfma_f32_16x16x32_bf16 v[48:51], a[100:103], a[4:7], v[48:51]
    s_add_u32 s96, s31, 0
    buffer_load_dwordx4 v7, s[12:15], s26 offen lds
    v_mfma_f32_16x16x32_bf16 v[48:51], a[104:107], a[8:11], v[48:51]
    s_mov_b32 m0, s93
    ds_read_b128 a[132:135], v2 offset:24576
    ds_read_b128 a[136:139], v1 offset:25600
    v_mfma_f32_16x16x32_bf16 v[48:51], a[108:111], a[12:15], v[48:51]
    s_add_u32 s97, s31, 4096
    ds_read_b128 a[140:143], v2 offset:25600
    ds_read_b128 a[144:147], v1 offset:26624
    v_mfma_f32_16x16x32_bf16 v[48:51], a[112:115], a[16:19], v[48:51]
    s_add_u32 s98, s31, 8192
    ds_read_b128 a[148:151], v2 offset:26624
    ds_read_b128 a[152:155], v1 offset:27648
    v_mfma_f32_16x16x32_bf16 v[48:51], a[116:119], a[20:23], v[48:51]
    s_add_u32 s99, s31, 12288
    buffer_load_dwordx4 v7, s[12:15], s26 offen offset:128 lds
    v_mfma_f32_16x16x32_bf16 v[48:51], a[120:123], a[24:27], v[48:51]
    s_add_u32 s100, s31, 16384
    ds_read_b128 a[156:159], v2 offset:27648
    v_accvgpr_write_b32 a176, v39
    v_mfma_f32_16x16x32_bf16 v[48:51], a[124:127], a[28:31], v[48:51]
    s_add_u32 s101, s31, 20480
    v_accvgpr_write_b32 a177, v39
    v_accvgpr_write_b32 a178, v39
    v_mfma_f32_16x16x32_bf16 v[52:55], a[124:127], a[60:63], 0
    s_mov_b32 m0, s94
    v_accvgpr_write_b32 a179, v39
    v_mov_b32 v36, v14
    v_mfma_f32_16x16x32_bf16 v[52:55], a[120:123], a[56:59], v[52:55]
    buffer_load_dwordx4 v7, s[12:15], s26 offen offset:256 lds
    v_mfma_f32_16x16x32_bf16 v[52:55], a[116:119], a[52:55], v[52:55]
    s_mov_b32 m0, s95
    v_mov_b32 v37, v15
    v_mov_b32 v38, v16
    v_permlane32_swap_b32 v14, v36
    v_permlane32_swap_b32 v15, v37
    v_mfma_f32_16x16x32_bf16 v[52:55], a[112:115], a[48:51], v[52:55]
    v_permlane32_swap_b32 v16, v38
    v_add_f32 v14, v14, v36
    v_bfe_u32 v41, v0, 3, 1
    v_lshlrev_b32 v41, 15, v41
    v_sub_u32 v40, v17, v41
    v_xor_b32 v41, 64, v40
    v_add_f32 v15, v15, v37
    v_add_f32 v16, v16, v38
    v_mov_b32 v36, v14
    v_mov_b32 v37, v15
    v_mfma_f32_16x16x32_bf16 v[52:55], a[108:111], a[44:47], v[52:55]
    buffer_load_dwordx4 v7, s[12:15], s26 offen offset:384 lds
    v_mov_b32 v38, v16
    v_permlane16_swap_b32 v14, v36
    v_permlane16_swap_b32 v15, v37
    v_permlane16_swap_b32 v16, v38
    v_add_f32 v14, v14, v36
    v_add_f32 v15, v15, v37
    v_mfma_f32_16x16x32_bf16 v[52:55], a[104:107], a[40:43], v[52:55]
    s_add_u32 s26, s26, 16384
    v_add_f32 v16, v16, v38
    v_fma_f32 v48, v48, s29, v8
    v_mfma_f32_16x16x32_bf16 v[52:55], a[100:103], a[36:39], v[52:55]
    s_waitcnt vmcnt(20)
    s_waitcnt lgkmcnt(0)
    s_barrier
    v_fma_f32 v49, v49, s29, v8
    v_mfma_f32_16x16x32_bf16 v[52:55], a[96:99], a[32:35], v[52:55]
    s_and_b32 s26, s26, 0x3ffff
    v_fma_f32 v50, v50, s29, v8
    v_fma_f32 v51, v51, s29, v8
    v_mfma_f32_16x16x32_bf16 v[56:59], a[96:99], a[64:67], 0
    s_add_u32 s45, s32, 8192
    v_exp_f32 v48, v48
    v_mfma_f32_16x16x32_bf16 v[56:59], a[100:103], a[68:71], v[56:59]
    s_mov_b32 m0, s64
    v_exp_f32 v49, v49
    v_mfma_f32_16x16x32_bf16 v[56:59], a[104:107], a[72:75], v[56:59]
    s_add_u32 s46, s32, 12288
    buffer_load_dwordx4 v7, s[4:7], s45 offen nt lds
    v_mfma_f32_16x16x32_bf16 v[56:59], a[108:111], a[76:79], v[56:59]
    s_mov_b32 m0, s65
    v_exp_f32 v50, v50
    v_mfma_f32_16x16x32_bf16 v[56:59], a[112:115], a[80:83], v[56:59]
    v_exp_f32 v51, v51
    v_mfma_f32_16x16x32_bf16 v[56:59], a[116:119], a[84:87], v[56:59]
    v_cvt_pk_bf16_f32 v84, v48, v49
    v_cvt_pk_bf16_f32 v85, v50, v51
    v_mfma_f32_16x16x32_bf16 v[56:59], a[120:123], a[88:91], v[56:59]
    buffer_load_dwordx4 v7, s[4:7], s45 offen offset:128 nt lds
    v_mfma_f32_16x16x32_bf16 v[56:59], a[124:127], a[92:95], v[56:59]
    s_mov_b32 m0, s66
    ds_read_b128 a[96:99], v1 offset:32768
    ds_read_b128 a[100:103], v2 offset:32768
    v_mfma_f32_16x16x32_bf16 v[60:63], a[128:131], a[0:3], 0
    ds_read_b128 a[104:107], v1 offset:33792
    ds_read_b128 a[108:111], v2 offset:33792
    v_mfma_f32_16x16x32_bf16 v[60:63], a[132:135], a[4:7], v[60:63]
    v_fma_f32 v52, v52, s29, v9
    v_fma_f32 v53, v53, s29, v9
    v_mfma_f32_16x16x32_bf16 v[60:63], a[136:139], a[8:11], v[60:63]
    buffer_load_dwordx4 v7, s[4:7], s45 offen offset:256 nt lds
    v_mfma_f32_16x16x32_bf16 v[60:63], a[140:143], a[12:15], v[60:63]
    s_mov_b32 m0, s67
    ds_read_b128 a[112:115], v1 offset:34816
    v_fma_f32 v54, v54, s29, v9
    v_mfma_f32_16x16x32_bf16 v[60:63], a[144:147], a[16:19], v[60:63]
    v_fma_f32 v55, v55, s29, v9
    v_accvgpr_write_b32 a224, v72
    v_mfma_f32_16x16x32_bf16 v[60:63], a[148:151], a[20:23], v[60:63]
    ds_read_b128 a[116:119], v2 offset:34816
    v_accvgpr_write_b32 a225, v73
    v_mfma_f32_16x16x32_bf16 v[60:63], a[152:155], a[24:27], v[60:63]
    buffer_load_dwordx4 v7, s[4:7], s45 offen offset:384 nt lds
    v_exp_f32 v52, v52
    v_exp_f32 v53, v53
    v_mfma_f32_16x16x32_bf16 v[60:63], a[156:159], a[28:31], v[60:63]
    s_mov_b32 m0, s68
    ds_read_b128 a[120:123], v1 offset:35840
    v_exp_f32 v54, v54
    v_exp_f32 v55, v55
    v_mfma_f32_16x16x32_bf16 v[64:67], a[156:159], a[60:63], 0
    s_add_u32 s45, s32, 16384
    ds_read_b128 a[124:127], v2 offset:35840
    v_cvt_pk_bf16_f32 v88, v52, v53
    v_cvt_pk_bf16_f32 v89, v54, v55
    v_mfma_f32_16x16x32_bf16 v[64:67], a[152:155], a[56:59], v[64:67]
    buffer_load_dwordx4 v7, s[4:7], s46 offen nt lds
    v_accvgpr_write_b32 a226, v74
    v_mfma_f32_16x16x32_bf16 v[64:67], a[148:151], a[52:55], v[64:67]
    s_mov_b32 m0, s69
    v_accvgpr_write_b32 a227, v75
    v_accvgpr_write_b32 a228, v76
    v_mfma_f32_16x16x32_bf16 v[64:67], a[144:147], a[48:51], v[64:67]
    v_accvgpr_write_b32 a229, v77
    v_accvgpr_write_b32 a230, v78
    v_mfma_f32_16x16x32_bf16 v[64:67], a[140:143], a[44:47], v[64:67]
    v_accvgpr_write_b32 a231, v79
    v_fma_f32 v56, v56, s29, v10
    v_mfma_f32_16x16x32_bf16 v[64:67], a[136:139], a[40:43], v[64:67]
    v_accvgpr_write_b32 a232, v80
    v_fma_f32 v57, v57, s29, v10
    v_accvgpr_write_b32 a233, v81
    v_fma_f32 v58, v58, s29, v10
    v_mfma_f32_16x16x32_bf16 v[64:67], a[132:135], a[36:39], v[64:67]
    v_fma_f32 v59, v59, s29, v10
    v_accvgpr_write_b32 a234, v82
    v_exp_f32 v56, v56
    v_accvgpr_write_b32 a235, v83
    v_exp_f32 v57, v57
    v_mfma_f32_16x16x32_bf16 v[64:67], a[128:131], a[32:35], v[64:67]
    buffer_load_dwordx4 v7, s[4:7], s46 offen offset:128 nt lds
    v_exp_f32 v58, v58
    v_exp_f32 v59, v59
    v_mfma_f32_16x16x32_bf16 v[68:71], a[128:131], a[64:67], 0
    s_mov_b32 m0, s70
    v_cvt_pk_bf16_f32 v92, v56, v57
    v_cvt_pk_bf16_f32 v93, v58, v59
    v_mfma_f32_16x16x32_bf16 v[68:71], a[132:135], a[68:71], v[68:71]
    v_fma_f32 v60, v60, s29, v8
    v_fma_f32 v61, v61, s29, v8
    v_mfma_f32_16x16x32_bf16 v[68:71], a[136:139], a[72:75], v[68:71]
    buffer_load_dwordx4 v7, s[4:7], s46 offen offset:256 nt lds
    v_mfma_f32_16x16x32_bf16 v[68:71], a[140:143], a[76:79], v[68:71]
    s_mov_b32 m0, s71
    v_fma_f32 v62, v62, s29, v8
    v_fma_f32 v63, v63, s29, v8
    v_mfma_f32_16x16x32_bf16 v[68:71], a[144:147], a[80:83], v[68:71]
    v_exp_f32 v60, v60
    v_mfma_f32_16x16x32_bf16 v[68:71], a[148:151], a[84:87], v[68:71]
    v_exp_f32 v61, v61
    v_mfma_f32_16x16x32_bf16 v[68:71], a[152:155], a[88:91], v[68:71]
    v_exp_f32 v62, v62
    v_mfma_f32_16x16x32_bf16 v[68:71], a[156:159], a[92:95], v[68:71]
    s_waitcnt lgkmcnt(0)
    buffer_load_dwordx4 v7, s[4:7], s46 offen offset:384 nt lds
    v_exp_f32 v63, v63
    v_mfma_f32_16x16x32_bf16 v[48:51], a[96:99], a[0:3], 0
    s_mov_b32 m0, s72
    v_cvt_pk_bf16_f32 v86, v60, v61
    v_cvt_pk_bf16_f32 v87, v62, v63
    v_mfma_f32_16x16x32_bf16 v[48:51], a[100:103], a[4:7], v[48:51]
    s_add_u32 s46, s32, 20480
    ds_read_b128 a[128:131], v1 offset:40960
    ds_read_b128 a[132:135], v2 offset:40960
    v_mfma_f32_16x16x32_bf16 a[180:183], a[176:179], v[84:87], 0
    ds_read_b128 a[136:139], v1 offset:41984
    ds_read_b128 a[140:143], v2 offset:41984
    v_mfma_f32_16x16x32_bf16 v[48:51], a[104:107], a[8:11], v[48:51]
    v_fma_f32 v64, v64, s29, v9
    v_fma_f32 v65, v65, s29, v9
    v_mfma_f32_16x16x32_bf16 v[48:51], a[108:111], a[12:15], v[48:51]
    ds_read_b128 a[144:147], v1 offset:43008
    ds_read_b128 a[148:151], v2 offset:43008
    v_mfma_f32_16x16x32_bf16 v[48:51], a[112:115], a[16:19], v[48:51]
    ds_read_b128 a[152:155], v1 offset:44032
    ds_read_b128 a[156:159], v2 offset:44032
    v_mfma_f32_16x16x32_bf16 v[48:51], a[116:119], a[20:23], v[48:51]
    v_fma_f32 v66, v66, s29, v9
    v_fma_f32 v67, v67, s29, v9
    v_mfma_f32_16x16x32_bf16 v[48:51], a[120:123], a[24:27], v[48:51]
    v_exp_f32 v64, v64
    v_exp_f32 v65, v65
    v_mfma_f32_16x16x32_bf16 v[48:51], a[124:127], a[28:31], v[48:51]
    v_exp_f32 v66, v66
    v_exp_f32 v67, v67
    v_mfma_f32_16x16x32_bf16 v[52:55], a[124:127], a[60:63], 0
    v_cvt_pk_bf16_f32 v90, v64, v65
    v_cvt_pk_bf16_f32 v91, v66, v67
    v_mfma_f32_16x16x32_bf16 v[52:55], a[120:123], a[56:59], v[52:55]
    v_fma_f32 v68, v68, s29, v10
    v_fma_f32 v69, v69, s29, v10
    v_mfma_f32_16x16x32_bf16 a[184:187], a[176:179], v[88:91], 0
    v_fma_f32 v70, v70, s29, v10
    v_fma_f32 v71, v71, s29, v10
    v_mfma_f32_16x16x32_bf16 v[52:55], a[116:119], a[52:55], v[52:55]
    v_exp_f32 v68, v68
    v_mfma_f32_16x16x32_bf16 v[52:55], a[112:115], a[48:51], v[52:55]
    v_exp_f32 v69, v69
    v_mfma_f32_16x16x32_bf16 v[52:55], a[108:111], a[44:47], v[52:55]
    s_waitcnt lgkmcnt(0)
    v_exp_f32 v70, v70
    v_mfma_f32_16x16x32_bf16 v[52:55], a[104:107], a[40:43], v[52:55]
    s_waitcnt vmcnt(18)
    v_exp_f32 v71, v71
    v_mfma_f32_16x16x32_bf16 v[52:55], a[100:103], a[36:39], v[52:55]
    s_barrier
    buffer_load_dwordx4 v7, s[4:7], s45 offen nt lds
    v_mfma_f32_16x16x32_bf16 v[52:55], a[96:99], a[32:35], v[52:55]
    s_mov_b32 m0, s73
    v_cvt_pk_bf16_f32 v94, v68, v69
    v_cvt_pk_bf16_f32 v95, v70, v71
    v_mfma_f32_16x16x32_bf16 v[56:59], a[96:99], a[64:67], 0
    v_fma_f32 v48, v48, s29, v8
    v_fma_f32 v49, v49, s29, v8
    v_mfma_f32_16x16x32_bf16 a[188:191], a[176:179], v[92:95], 0
    v_fma_f32 v50, v50, s29, v8
    v_fma_f32 v51, v51, s29, v8
    v_mfma_f32_16x16x32_bf16 v[56:59], a[100:103], a[68:71], v[56:59]
    buffer_load_dwordx4 v7, s[4:7], s45 offen offset:128 nt lds
    v_mfma_f32_16x16x32_bf16 v[56:59], a[104:107], a[72:75], v[56:59]
    s_mov_b32 m0, s74
    v_exp_f32 v48, v48
    v_mfma_f32_16x16x32_bf16 v[56:59], a[108:111], a[76:79], v[56:59]
    v_exp_f32 v49, v49
    v_mfma_f32_16x16x32_bf16 v[56:59], a[112:115], a[80:83], v[56:59]
    v_exp_f32 v50, v50
    v_mfma_f32_16x16x32_bf16 v[56:59], a[116:119], a[84:87], v[56:59]
    buffer_load_dwordx4 v7, s[4:7], s45 offen offset:256 nt lds
    v_mfma_f32_16x16x32_bf16 v[56:59], a[120:123], a[88:91], v[56:59]
    s_mov_b32 m0, s75
    v_exp_f32 v51, v51
    v_mfma_f32_16x16x32_bf16 v[56:59], a[124:127], a[92:95], v[56:59]
    v_cvt_pk_bf16_f32 v72, v48, v49
    v_cvt_pk_bf16_f32 v73, v50, v51
    v_mfma_f32_16x16x32_bf16 v[60:63], a[128:131], a[0:3], 0
    ds_read_b128 a[96:99], v1 offset:49152
    ds_read_b128 a[100:103], v2 offset:49152
    v_mfma_f32_16x16x32_bf16 v[60:63], a[132:135], a[4:7], v[60:63]
    buffer_load_dwordx4 v7, s[4:7], s45 offen offset:384 nt lds
    v_mfma_f32_16x16x32_bf16 v[60:63], a[136:139], a[8:11], v[60:63]
    s_mov_b32 m0, s76
    ds_read_b128 a[104:107], v1 offset:50176
    ds_read_b128 a[108:111], v2 offset:50176
    v_mfma_f32_16x16x32_bf16 v[60:63], a[140:143], a[12:15], v[60:63]
    v_fma_f32 v52, v52, s29, v9
    v_fma_f32 v53, v53, s29, v9
    v_mfma_f32_16x16x32_bf16 v[60:63], a[144:147], a[16:19], v[60:63]
    ds_read_b128 a[112:115], v1 offset:51200
    v_fma_f32 v54, v54, s29, v9
    v_mfma_f32_16x16x32_bf16 v[60:63], a[148:151], a[20:23], v[60:63]
    v_fma_f32 v55, v55, s29, v9
    v_accvgpr_write_b32 a236, v84
    v_mfma_f32_16x16x32_bf16 v[60:63], a[152:155], a[24:27], v[60:63]
    ds_read_b128 a[116:119], v2 offset:51200
    v_exp_f32 v52, v52
    v_exp_f32 v53, v53
    v_mfma_f32_16x16x32_bf16 v[60:63], a[156:159], a[28:31], v[60:63]
    ds_read_b128 a[120:123], v1 offset:52224
    v_exp_f32 v54, v54
    v_exp_f32 v55, v55
    v_mfma_f32_16x16x32_bf16 v[64:67], a[156:159], a[60:63], 0
    ds_read_b128 a[124:127], v2 offset:52224
    v_cvt_pk_bf16_f32 v76, v52, v53
    v_cvt_pk_bf16_f32 v77, v54, v55
    v_mfma_f32_16x16x32_bf16 v[64:67], a[152:155], a[56:59], v[64:67]
    v_accvgpr_write_b32 a237, v85
    v_accvgpr_write_b32 a238, v86
    v_mfma_f32_16x16x32_bf16 v[64:67], a[148:151], a[52:55], v[64:67]
    v_accvgpr_write_b32 a239, v87
    v_accvgpr_write_b32 a240, v88
    v_mfma_f32_16x16x32_bf16 v[64:67], a[144:147], a[48:51], v[64:67]
    v_accvgpr_write_b32 a241, v89
    v_accvgpr_write_b32 a242, v90
    v_mfma_f32_16x16x32_bf16 v[64:67], a[140:143], a[44:47], v[64:67]
    v_accvgpr_write_b32 a243, v91
    v_fma_f32 v56, v56, s29, v10
    v_mfma_f32_16x16x32_bf16 v[64:67], a[136:139], a[40:43], v[64:67]
    v_accvgpr_write_b32 a244, v92
    v_fma_f32 v57, v57, s29, v10
    v_accvgpr_write_b32 a245, v93
    v_fma_f32 v58, v58, s29, v10
    v_mfma_f32_16x16x32_bf16 v[64:67], a[132:135], a[36:39], v[64:67]
    v_fma_f32 v59, v59, s29, v10
    v_accvgpr_write_b32 a246, v94
    v_exp_f32 v56, v56
    v_accvgpr_write_b32 a247, v95
    v_exp_f32 v57, v57
    v_mfma_f32_16x16x32_bf16 v[64:67], a[128:131], a[32:35], v[64:67]
    v_exp_f32 v58, v58
    v_exp_f32 v59, v59
    v_mfma_f32_16x16x32_bf16 v[68:71], a[128:131], a[64:67], 0
    v_cvt_pk_bf16_f32 v80, v56, v57
    v_cvt_pk_bf16_f32 v81, v58, v59
    v_mfma_f32_16x16x32_bf16 v[68:71], a[132:135], a[68:71], v[68:71]
    v_fma_f32 v60, v60, s29, v8
    v_fma_f32 v61, v61, s29, v8
    v_mfma_f32_16x16x32_bf16 v[68:71], a[136:139], a[72:75], v[68:71]
    v_fma_f32 v62, v62, s29, v8
    v_fma_f32 v63, v63, s29, v8
    v_mfma_f32_16x16x32_bf16 v[68:71], a[140:143], a[76:79], v[68:71]
    v_exp_f32 v60, v60
    v_mfma_f32_16x16x32_bf16 v[68:71], a[144:147], a[80:83], v[68:71]
    v_exp_f32 v61, v61
    v_mfma_f32_16x16x32_bf16 v[68:71], a[148:151], a[84:87], v[68:71]
    v_exp_f32 v62, v62
    v_mfma_f32_16x16x32_bf16 v[68:71], a[152:155], a[88:91], v[68:71]
    v_exp_f32 v63, v63
    v_mfma_f32_16x16x32_bf16 v[68:71], a[156:159], a[92:95], v[68:71]
    s_waitcnt lgkmcnt(0)
    v_cvt_pk_bf16_f32 v74, v60, v61
    v_cvt_pk_bf16_f32 v75, v62, v63
    v_mfma_f32_16x16x32_bf16 v[48:51], a[96:99], a[0:3], 0
    ds_read_b128 a[128:131], v1 offset:57344
    ds_read_b128 a[132:135], v2 offset:57344
    v_mfma_f32_16x16x32_bf16 a[180:183], a[176:179], v[72:75], a[180:183]
    ds_read_b128 a[136:139], v1 offset:58368
    ds_read_b128 a[140:143], v2 offset:58368
    v_mfma_f32_16x16x32_bf16 v[48:51], a[100:103], a[4:7], v[48:51]
    v_fma_f32 v64, v64, s29, v9
    v_fma_f32 v65, v65, s29, v9
    v_mfma_f32_16x16x32_bf16 v[48:51], a[104:107], a[8:11], v[48:51]
    ds_read_b128 a[144:147], v1 offset:59392
    ds_read_b128 a[148:151], v2 offset:59392
    v_mfma_f32_16x16x32_bf16 v[48:51], a[108:111], a[12:15], v[48:51]
    ds_read_b128 a[152:155], v1 offset:60416
    ds_read_b128 a[156:159], v2 offset:60416
    v_mfma_f32_16x16x32_bf16 v[48:51], a[112:115], a[16:19], v[48:51]
    v_fma_f32 v66, v66, s29, v9
    v_fma_f32 v67, v67, s29, v9
    v_mfma_f32_16x16x32_bf16 v[48:51], a[116:119], a[20:23], v[48:51]
    v_exp_f32 v64, v64
    v_mfma_f32_16x16x32_bf16 v[48:51], a[120:123], a[24:27], v[48:51]
    ds_read_b64_tr_b16 a[160:161], v3 offset:0
    ds_read_b64_tr_b16 a[162:163], v3 offset:8192
    v_exp_f32 v65, v65
    v_mfma_f32_16x16x32_bf16 v[48:51], a[124:127], a[28:31], v[48:51]
    v_exp_f32 v66, v66
    v_exp_f32 v67, v67
    v_mfma_f32_16x16x32_bf16 v[52:55], a[124:127], a[60:63], 0
    v_cvt_pk_bf16_f32 v78, v64, v65
    v_cvt_pk_bf16_f32 v79, v66, v67
    v_mfma_f32_16x16x32_bf16 v[52:55], a[120:123], a[56:59], v[52:55]
    v_fma_f32 v68, v68, s29, v10
    v_fma_f32 v69, v69, s29, v10
    v_mfma_f32_16x16x32_bf16 a[184:187], a[176:179], v[76:79], a[184:187]
    v_fma_f32 v70, v70, s29, v10
    v_fma_f32 v71, v71, s29, v10
    v_mfma_f32_16x16x32_bf16 v[52:55], a[116:119], a[52:55], v[52:55]
    ds_read_b64_tr_b16 a[248:249], v4 offset:0
    ds_read_b64_tr_b16 a[250:251], v4 offset:8192
    v_mfma_f32_16x16x32_bf16 v[52:55], a[112:115], a[48:51], v[52:55]
    v_exp_f32 v68, v68
    v_mfma_f32_16x16x32_bf16 v[52:55], a[108:111], a[44:47], v[52:55]
    v_exp_f32 v69, v69
    v_mfma_f32_16x16x32_bf16 v[52:55], a[104:107], a[40:43], v[52:55]
    s_waitcnt lgkmcnt(2)
    v_exp_f32 v70, v70
    v_mfma_f32_16x16x32_bf16 v[52:55], a[100:103], a[36:39], v[52:55]
    s_waitcnt vmcnt(12)
    v_exp_f32 v71, v71
    v_mfma_f32_16x16x32_bf16 v[52:55], a[96:99], a[32:35], v[52:55]
    s_barrier
    ds_read_b64_tr_b16 a[164:165], v3 offset:16384
    ds_read_b64_tr_b16 a[166:167], v3 offset:24576
    v_mfma_f32_16x16x32_bf16 v[56:59], a[96:99], a[64:67], 0
    ds_read_b64_tr_b16 a[168:169], v3 offset:32768
    ds_read_b64_tr_b16 a[170:171], v3 offset:40960
    v_mfma_f32_16x16x32_bf16 v[56:59], a[100:103], a[68:71], v[56:59]
    buffer_load_dwordx4 v7, s[4:7], s46 offen nt lds
    v_mfma_f32_16x16x32_bf16 v[56:59], a[104:107], a[72:75], v[56:59]
    s_mov_b32 m0, s77
    ds_read_b64_tr_b16 a[172:173], v3 offset:49152
    ds_read_b64_tr_b16 a[174:175], v3 offset:57344
    v_mfma_f32_16x16x32_bf16 v[56:59], a[108:111], a[76:79], v[56:59]
    ds_read_b64_tr_b16 a[252:253], v4 offset:16384
    ds_read_b64_tr_b16 a[254:255], v4 offset:24576
    v_cvt_pk_bf16_f32 v82, v68, v69
    v_cvt_pk_bf16_f32 v83, v70, v71
    v_mfma_f32_16x16x32_bf16 v[56:59], a[112:115], a[80:83], v[56:59]
    ds_read_b64_tr_b16 a[96:97], v4 offset:32768
    ds_read_b64_tr_b16 a[98:99], v4 offset:40960
    v_mfma_f32_16x16x32_bf16 a[188:191], a[176:179], v[80:83], a[188:191]
    buffer_load_dwordx4 v7, s[4:7], s46 offen offset:128 nt lds
    v_mfma_f32_16x16x32_bf16 v[56:59], a[116:119], a[84:87], v[56:59]
    s_mov_b32 m0, s78
    ds_read_b64_tr_b16 a[100:101], v4 offset:49152
    ds_read_b64_tr_b16 a[102:103], v4 offset:57344
    v_fma_f32 v48, v48, s29, v8
    v_fma_f32 v49, v49, s29, v8
    v_fma_f32 v50, v50, s29, v8
    v_mfma_f32_16x16x32_bf16 v[56:59], a[120:123], a[88:91], v[56:59]
    ds_read_b64_tr_b16 a[104:105], v5 offset:0
    ds_read_b64_tr_b16 a[106:107], v5 offset:8192
    v_fma_f32 v51, v51, s29, v8
    v_exp_f32 v48, v48
    v_exp_f32 v49, v49
    v_mfma_f32_16x16x32_bf16 v[56:59], a[124:127], a[92:95], v[56:59]
    buffer_load_dwordx4 v7, s[4:7], s46 offen offset:256 nt lds
    v_mfma_f32_16x16x32_bf16 v[60:63], a[128:131], a[0:3], 0
    s_mov_b32 m0, s79
    ds_read_b64_tr_b16 a[108:109], v5 offset:16384
    ds_read_b64_tr_b16 a[110:111], v5 offset:24576
    v_exp_f32 v50, v50
    v_exp_f32 v51, v51
    v_cvt_pk_bf16_f32 v84, v48, v49
    v_cvt_pk_bf16_f32 v85, v50, v51
    v_mfma_f32_16x16x32_bf16 v[60:63], a[132:135], a[4:7], v[60:63]
    ds_read_b64_tr_b16 a[112:113], v5 offset:32768
    ds_read_b64_tr_b16 a[114:115], v5 offset:40960
    v_mfma_f32_16x16x32_bf16 v[60:63], a[136:139], a[8:11], v[60:63]
    ds_read_b64_tr_b16 a[116:117], v5 offset:49152
    ds_read_b64_tr_b16 a[118:119], v5 offset:57344
    v_mfma_f32_16x16x32_bf16 v[60:63], a[140:143], a[12:15], v[60:63]
    buffer_load_dwordx4 v7, s[4:7], s46 offen offset:384 nt lds
    v_mfma_f32_16x16x32_bf16 v[60:63], a[144:147], a[16:19], v[60:63]
    s_mov_b32 m0, s64
    ds_read_b64_tr_b16 a[120:121], v6 offset:0
    ds_read_b64_tr_b16 a[122:123], v6 offset:8192
    v_fma_f32 v52, v52, s29, v9
    v_mfma_f32_16x16x32_bf16 v[60:63], a[148:151], a[20:23], v[60:63]
    v_fma_f32 v53, v53, s29, v9
    v_fma_f32 v54, v54, s29, v9
    v_mfma_f32_16x16x32_bf16 v[60:63], a[152:155], a[24:27], v[60:63]
    ds_read_b64_tr_b16 a[124:125], v6 offset:16384
    ds_read_b64_tr_b16 a[126:127], v6 offset:24576
    v_fma_f32 v55, v55, s29, v9
    v_exp_f32 v52, v52
    v_exp_f32 v53, v53
    v_mfma_f32_16x16x32_bf16 v[60:63], a[156:159], a[28:31], v[60:63]
    v_exp_f32 v54, v54
    v_exp_f32 v55, v55
    v_mfma_f32_16x16x32_bf16 v[64:67], a[156:159], a[60:63], 0
    v_cvt_pk_bf16_f32 v88, v52, v53
    v_cvt_pk_bf16_f32 v89, v54, v55
    v_mfma_f32_16x16x32_bf16 v[64:67], a[152:155], a[56:59], v[64:67]
    s_waitcnt vmcnt(20)
    ds_read_b128 a[0:3], v19 offset:0
    ds_read_b128 a[4:7], v20 offset:0
    v_mfma_f32_16x16x32_bf16 v[64:67], a[148:151], a[52:55], v[64:67]
    ds_read_b128 a[8:11], v19 offset:1024
    ds_read_b128 a[12:15], v20 offset:1024
    v_mfma_f32_16x16x32_bf16 v[64:67], a[144:147], a[48:51], v[64:67]
    ds_read_b128 a[16:19], v19 offset:2048
    ds_read_b128 a[20:23], v20 offset:2048
    v_mfma_f32_16x16x32_bf16 v[64:67], a[140:143], a[44:47], v[64:67]
    ds_read_b128 a[24:27], v19 offset:3072
    v_fma_f32 v56, v56, s29, v10
    v_mfma_f32_16x16x32_bf16 v[64:67], a[136:139], a[40:43], v[64:67]
    ds_read_b128 a[28:31], v20 offset:3072
    v_fma_f32 v57, v57, s29, v10
    v_fma_f32 v58, v58, s29, v10
    v_mfma_f32_16x16x32_bf16 v[64:67], a[132:135], a[36:39], v[64:67]
    v_fma_f32 v59, v59, s29, v10
    v_exp_f32 v56, v56
    v_exp_f32 v57, v57
    v_mfma_f32_16x16x32_bf16 v[64:67], a[128:131], a[32:35], v[64:67]
    v_exp_f32 v58, v58
    v_mfma_f32_16x16x32_bf16 v[68:71], a[128:131], a[64:67], 0
    ds_read_b64_tr_b16 a[128:129], v6 offset:32768
    ds_read_b64_tr_b16 a[130:131], v6 offset:40960
    v_exp_f32 v59, v59
    v_cvt_pk_bf16_f32 v92, v56, v57
    v_cvt_pk_bf16_f32 v93, v58, v59
    v_mfma_f32_16x16x32_bf16 v[68:71], a[132:135], a[68:71], v[68:71]
    ds_read_b64_tr_b16 a[132:133], v6 offset:49152
    ds_read_b64_tr_b16 a[134:135], v6 offset:57344
    v_mfma_f32_16x16x32_bf16 v[68:71], a[136:139], a[72:75], v[68:71]
    v_fma_f32 v60, v60, s29, v8
    v_fma_f32 v61, v61, s29, v8
    v_mfma_f32_16x16x32_bf16 v[68:71], a[140:143], a[76:79], v[68:71]
    v_fma_f32 v62, v62, s29, v8
    v_fma_f32 v63, v63, s29, v8
    v_mfma_f32_16x16x32_bf16 v[68:71], a[144:147], a[80:83], v[68:71]
    v_exp_f32 v60, v60
    v_mfma_f32_16x16x32_bf16 v[68:71], a[148:151], a[84:87], v[68:71]
    v_exp_f32 v61, v61
    v_mfma_f32_16x16x32_bf16 v[68:71], a[152:155], a[88:91], v[68:71]
    v_exp_f32 v62, v62
    v_mfma_f32_16x16x32_bf16 v[68:71], a[156:159], a[92:95], v[68:71]
    v_exp_f32 v63, v63
    v_mfma_f32_16x16x32_bf16 v[96:99], a[160:163], a[224:227], v[96:99]
    s_waitcnt lgkmcnt(2)
    v_cvt_pk_bf16_f32 v86, v60, v61
    v_cvt_pk_bf16_f32 v87, v62, v63
    v_mfma_f32_16x16x32_bf16 v[96:99], a[164:167], a[236:239], v[96:99]
    v_fma_f32 v64, v64, s29, v9
    v_fma_f32 v65, v65, s29, v9
    v_mfma_f32_16x16x32_bf16 a[180:183], a[176:179], v[84:87], a[180:183]
    v_fma_f32 v66, v66, s29, v9
    v_fma_f32 v67, v67, s29, v9
    v_mfma_f32_16x16x32_bf16 v[96:99], a[168:171], v[72:75], v[96:99]
    v_exp_f32 v64, v64
    v_mfma_f32_16x16x32_bf16 v[96:99], a[172:175], v[84:87], v[96:99]
    v_exp_f32 v65, v65
    v_mfma_f32_16x16x32_bf16 v[108:111], a[100:103], v[84:87], v[108:111]
    v_exp_f32 v66, v66
    v_mfma_f32_16x16x32_bf16 v[108:111], a[96:99], v[72:75], v[108:111]
    v_exp_f32 v67, v67
    v_mfma_f32_16x16x32_bf16 v[108:111], a[252:255], a[236:239], v[108:111]
    v_cvt_pk_bf16_f32 v90, v64, v65
    v_cvt_pk_bf16_f32 v91, v66, v67
    v_accvgpr_read_b32 v36, a180
    v_add_f32 v14, v14, v36
    v_mfma_f32_16x16x32_bf16 a[184:187], a[176:179], v[88:91], a[184:187]
    v_rcp_f32 v26, v14
    v_mfma_f32_16x16x32_bf16 v[108:111], a[248:251], a[224:227], v[108:111]
    v_fma_f32 v68, v68, s29, v10
    v_fma_f32 v69, v69, s29, v10
    v_mfma_f32_16x16x32_bf16 v[120:123], a[104:107], a[224:227], v[120:123]
    v_fma_f32 v70, v70, s29, v10
    v_fma_f32 v71, v71, s29, v10
    v_mfma_f32_16x16x32_bf16 v[120:123], a[108:111], a[236:239], v[120:123]
    v_exp_f32 v68, v68
    v_mfma_f32_16x16x32_bf16 v[120:123], a[112:115], v[72:75], v[120:123]
    v_exp_f32 v69, v69
    v_mfma_f32_16x16x32_bf16 v[120:123], a[116:119], v[84:87], v[120:123]
    s_waitcnt lgkmcnt(0)
    v_exp_f32 v70, v70
    v_exp_f32 v71, v71
    v_mfma_f32_16x16x32_bf16 v[132:135], a[132:135], v[84:87], v[132:135]
    v_cvt_pk_bf16_f32 v94, v68, v69
    v_cvt_pk_bf16_f32 v95, v70, v71
    v_accvgpr_read_b32 v37, a184
    v_add_f32 v15, v15, v37
    v_mfma_f32_16x16x32_bf16 a[188:191], a[176:179], v[92:95], a[188:191]
    v_rcp_f32 v27, v15
    v_mul_f32 v96, v96, v26
    v_mfma_f32_16x16x32_bf16 v[132:135], a[128:131], v[72:75], v[132:135]
    v_mul_f32 v97, v97, v26
    v_mul_f32 v98, v98, v26
    v_mul_f32 v99, v99, v26
    v_cvt_pk_bf16_f32 v96, v96, v97
    v_cvt_pk_bf16_f32 v97, v98, v99
    v_mfma_f32_16x16x32_bf16 v[132:135], a[124:127], a[236:239], v[132:135]
    ds_write_b64 v30, v[96:97] offset:0
    v_mfma_f32_16x16x32_bf16 v[132:135], a[120:123], a[224:227], v[132:135]
    s_waitcnt vmcnt(8)
    ds_read_b128 a[32:35], v40 offset:0
    ds_read_b128 a[36:39], v41 offset:0
    v_mfma_f32_16x16x32_bf16 v[100:103], a[160:163], a[228:231], v[100:103]
    s_mov_b32 s3, 0x30000
    ds_read_b128 a[40:43], v40 offset:1024
    ds_read_b128 a[44:47], v41 offset:1024
    v_mfma_f32_16x16x32_bf16 v[100:103], a[164:167], a[240:243], v[100:103]
    s_mov_b32 s27, 0
    ds_read_b128 a[48:51], v40 offset:2048
    ds_read_b128 a[52:55], v41 offset:2048
    v_mul_f32 v108, v108, v26
    v_mul_f32 v109, v109, v26
    v_mul_f32 v110, v110, v26
    v_mul_f32 v111, v111, v26
    v_cvt_pk_bf16_f32 v108, v108, v109
    v_cvt_pk_bf16_f32 v109, v110, v111
    v_mfma_f32_16x16x32_bf16 v[100:103], a[168:171], v[76:79], v[100:103]
    s_mov_b32 s39, 0
    ds_write_b64 v31, v[108:109] offset:0
    v_mfma_f32_16x16x32_bf16 v[100:103], a[172:175], v[88:91], v[100:103]
    ds_read_b128 a[56:59], v40 offset:3072
    ds_read_b128 a[60:63], v41 offset:3072
    v_accvgpr_read_b32 v38, a188
    v_add_f32 v16, v16, v38
    v_rcp_f32 v28, v16
    v_mfma_f32_16x16x32_bf16 v[112:115], a[100:103], v[88:91], v[112:115]
    ds_read_b64_tr_b16 a[136:137], v3 offset:1024
    ds_read_b64_tr_b16 a[138:139], v3 offset:9216
    v_mfma_f32_16x16x32_bf16 v[112:115], a[96:99], v[76:79], v[112:115]
    ds_read_b64_tr_b16 a[140:141], v3 offset:17408
    ds_read_b64_tr_b16 a[142:143], v3 offset:25600
    v_mfma_f32_16x16x32_bf16 v[112:115], a[252:255], a[240:243], v[112:115]
    ds_read_b64_tr_b16 a[144:145], v3 offset:33792
    ds_read_b64_tr_b16 a[146:147], v3 offset:41984
    v_mul_f32 v120, v120, v26
    v_mul_f32 v121, v121, v26
    v_mul_f32 v122, v122, v26
    v_mul_f32 v123, v123, v26
    v_cvt_pk_bf16_f32 v120, v120, v121
    v_cvt_pk_bf16_f32 v121, v122, v123
    v_add_f32 v34, v14, v15
    v_add_f32 v34, v34, v16
    v_cmp_ngt_f32 vcc, s36, v34
    s_cmp_lg_u64 vcc, 0
    s_cselect_b32 s35, 1, 0
    ds_write_b64 v32, v[120:121] offset:0
    v_mfma_f32_16x16x32_bf16 v[112:115], a[248:251], a[228:231], v[112:115]
    ds_read_b64_tr_b16 a[148:149], v3 offset:50176
    ds_read_b64_tr_b16 a[150:151], v3 offset:58368
    v_mfma_f32_16x16x32_bf16 v[124:127], a[104:107], a[228:231], v[124:127]
    ds_read_b64_tr_b16 a[152:153], v4 offset:1024
    ds_read_b64_tr_b16 a[154:155], v4 offset:9216
    v_mov_b32 v34, s35
    v_mul_f32 v132, v132, v26
    v_mfma_f32_16x16x32_bf16 v[124:127], a[108:111], a[240:243], v[124:127]
    ds_write_b32 v21, v34
    v_mfma_f32_16x16x32_bf16 v[124:127], a[112:115], v[76:79], v[124:127]
    ds_read_b64_tr_b16 a[156:157], v4 offset:17408
    ds_read_b64_tr_b16 a[158:159], v4 offset:25600
    v_mfma_f32_16x16x32_bf16 v[124:127], a[116:119], v[88:91], v[124:127]
    s_waitcnt lgkmcnt(8)
    buffer_load_dwordx4 v7, s[8:11], s25 offen lds
    v_mfma_f32_16x16x32_bf16 v[136:139], a[132:135], v[88:91], v[136:139]
    s_mov_b32 m0, s65
    ds_read_b64_tr_b16 a[176:177], v4 offset:33792
    ds_read_b64_tr_b16 a[178:179], v4 offset:41984
    v_mul_f32 v133, v133, v26
    v_mul_f32 v134, v134, v26
    v_mul_f32 v135, v135, v26
    v_cvt_pk_bf16_f32 v132, v132, v133
    v_cvt_pk_bf16_f32 v133, v134, v135
    v_mfma_f32_16x16x32_bf16 v[136:139], a[128:131], v[76:79], v[136:139]
    ds_write_b64 v33, v[132:133] offset:0
    ds_read_b128 v[96:99], v24 offset:0
    ds_read_b128 v[108:111], v24 offset:1024
    v_mfma_f32_16x16x32_bf16 v[136:139], a[124:127], a[240:243], v[136:139]
    ds_read_b64_tr_b16 a[180:181], v4 offset:50176
    ds_read_b64_tr_b16 a[182:183], v4 offset:58368
    v_mfma_f32_16x16x32_bf16 v[136:139], a[120:123], a[228:231], v[136:139]
    ds_read_b64_tr_b16 a[184:185], v5 offset:1024
    ds_read_b64_tr_b16 a[186:187], v5 offset:9216
    v_mfma_f32_16x16x32_bf16 v[104:107], a[160:163], a[232:235], v[104:107]
    buffer_load_dwordx4 v7, s[8:11], s25 offen offset:128 lds
    v_mfma_f32_16x16x32_bf16 v[104:107], a[164:167], a[244:247], v[104:107]
    s_mov_b32 m0, s66
    ds_read_b64_tr_b16 a[188:189], v5 offset:17408
    ds_read_b64_tr_b16 a[190:191], v5 offset:25600
    v_mul_f32 v100, v100, v27
    v_mul_f32 v101, v101, v27
    v_mul_f32 v102, v102, v27
    v_mul_f32 v103, v103, v27
    v_cvt_pk_bf16_f32 v100, v100, v101
    v_cvt_pk_bf16_f32 v101, v102, v103
    v_mfma_f32_16x16x32_bf16 v[104:107], a[168:171], v[80:83], v[104:107]
    ds_write_b64 v30, v[100:101] offset:2048
    v_mfma_f32_16x16x32_bf16 v[104:107], a[172:175], v[92:95], v[104:107]
    s_waitcnt lgkmcnt(6)
    buffer_store_dwordx4 v[96:99], v23, s[16:19], s96 offen
    ds_read_b64_tr_b16 a[160:161], v5 offset:33792
    ds_read_b64_tr_b16 a[162:163], v5 offset:41984
    ds_read_b64_tr_b16 a[164:165], v5 offset:50176
    ds_read_b64_tr_b16 a[166:167], v5 offset:58368
    v_mfma_f32_16x16x32_bf16 v[116:119], a[100:103], v[92:95], v[116:119]
    ds_read_b64_tr_b16 a[168:169], v6 offset:1024
    ds_read_b64_tr_b16 a[170:171], v6 offset:9216
    v_mul_f32 v112, v112, v27
    v_mul_f32 v113, v113, v27
    v_mul_f32 v114, v114, v27
    v_mul_f32 v115, v115, v27
    v_cvt_pk_bf16_f32 v112, v112, v113
    v_cvt_pk_bf16_f32 v113, v114, v115
    v_mfma_f32_16x16x32_bf16 v[116:119], a[96:99], v[80:83], v[116:119]
    ds_write_b64 v31, v[112:113] offset:2048
    v_mfma_f32_16x16x32_bf16 v[116:119], a[252:255], a[244:247], v[116:119]
    buffer_load_dwordx4 v7, s[8:11], s25 offen offset:256 lds
    v_mfma_f32_16x16x32_bf16 v[116:119], a[248:251], a[232:235], v[116:119]
    s_mov_b32 m0, s67
    ds_read_b64_tr_b16 a[172:173], v6 offset:17408
    ds_read_b64_tr_b16 a[174:175], v6 offset:25600
    v_mfma_f32_16x16x32_bf16 v[128:131], a[104:107], a[232:235], v[128:131]
    ds_read_b64_tr_b16 a[248:249], v6 offset:33792
    ds_read_b64_tr_b16 a[250:251], v6 offset:41984
    v_mfma_f32_16x16x32_bf16 v[128:131], a[108:111], a[244:247], v[128:131]
    ds_read_b64_tr_b16 a[252:253], v6 offset:50176
    ds_read_b64_tr_b16 a[254:255], v6 offset:58368
    v_mul_f32 v124, v124, v27
    v_mul_f32 v125, v125, v27
    v_mul_f32 v126, v126, v27
    v_mul_f32 v127, v127, v27
    v_cvt_pk_bf16_f32 v124, v124, v125
    v_cvt_pk_bf16_f32 v125, v126, v127
    v_mfma_f32_16x16x32_bf16 v[128:131], a[112:115], v[80:83], v[128:131]
    ds_write_b64 v32, v[124:125] offset:2048
    v_mfma_f32_16x16x32_bf16 v[128:131], a[116:119], v[92:95], v[128:131]
    buffer_store_dwordx4 v[108:111], v23, s[16:19], s97 offen
    s_barrier
    ds_read_b32 v35, v22
    v_mul_f32 v136, v136, v27
    v_mul_f32 v137, v137, v27
    v_mul_f32 v138, v138, v27
    v_mul_f32 v139, v139, v27
    v_cvt_pk_bf16_f32 v136, v136, v137
    v_cvt_pk_bf16_f32 v137, v138, v139
    v_mfma_f32_16x16x32_bf16 v[140:143], a[132:135], v[92:95], v[140:143]
    ds_write_b64 v33, v[136:137] offset:2048
    ds_read_b128 v[100:103], v24 offset:2048
    ds_read_b128 v[112:115], v24 offset:3072
    v_mfma_f32_16x16x32_bf16 v[140:143], a[128:131], v[80:83], v[140:143]
    buffer_load_dwordx4 v7, s[8:11], s25 offen offset:384 lds
    v_mfma_f32_16x16x32_bf16 v[140:143], a[124:127], a[244:247], v[140:143]
    s_mov_b32 m0, s68
    v_mul_f32 v104, v104, v28
    v_mul_f32 v105, v105, v28
    v_mfma_f32_16x16x32_bf16 v[140:143], a[120:123], a[232:235], v[140:143]
    v_mul_f32 v106, v106, v28
    v_mul_f32 v107, v107, v28
    v_cvt_pk_bf16_f32 v104, v104, v105
    v_cvt_pk_bf16_f32 v105, v106, v107
    v_mfma_f32_16x16x32_bf16 v[144:147], a[136:139], a[224:227], v[144:147]
    ds_write_b64 v30, v[104:105] offset:4096
    v_mfma_f32_16x16x32_bf16 v[144:147], a[140:143], a[236:239], v[144:147]
    s_waitcnt lgkmcnt(4)
    v_cmp_ne_u32 vcc, 0, v35
    s_cmp_lg_u64 vcc, 0
    v_mfma_f32_16x16x32_bf16 v[144:147], a[144:147], v[72:75], v[144:147]
    s_cselect_b32 s35, 1, 0
    s_andn2_b32 s35, s35, s44
    s_cbranch_scc1 L_redo
    s_add_u32 s25, s25, 16384
    v_mfma_f32_16x16x32_bf16 v[144:147], a[148:151], v[84:87], v[144:147]
    s_and_b32 s25, s25, 0x3ffff
    v_mul_f32 v116, v116, v28
    v_mul_f32 v117, v117, v28
    v_mul_f32 v118, v118, v28
    v_mul_f32 v119, v119, v28
    v_cvt_pk_bf16_f32 v116, v116, v117
    v_cvt_pk_bf16_f32 v117, v118, v119
    v_mfma_f32_16x16x32_bf16 v[156:159], a[180:183], v[84:87], v[156:159]
    s_mov_b32 s28, 1
    s_waitcnt lgkmcnt(0)
    buffer_store_dwordx4 v[100:103], v23, s[16:19], s98 offen
    ds_write_b64 v31, v[116:117] offset:4096
    v_mul_f32 v128, v128, v28
    v_mfma_f32_16x16x32_bf16 v[156:159], a[176:179], v[72:75], v[156:159]
    s_mov_b32 s44, 0
    v_mul_f32 v129, v129, v28
    v_mul_f32 v130, v130, v28
    v_mfma_f32_16x16x32_bf16 v[156:159], a[156:159], a[236:239], v[156:159]
    s_mov_b64 s[42:43], 0
    v_mul_f32 v131, v131, v28
    v_cvt_pk_bf16_f32 v128, v128, v129
    v_mfma_f32_16x16x32_bf16 v[156:159], a[152:155], a[224:227], v[156:159]
    s_mov_b32 s31, s32
    buffer_load_dwordx4 v7, s[8:11], s25 offen lds
    v_cvt_pk_bf16_f32 v129, v130, v131
    v_mfma_f32_16x16x32_bf16 v[168:171], a[184:187], a[224:227], v[168:171]
    s_mov_b32 m0, s69
    ds_write_b64 v32, v[128:129] offset:4096
    v_mfma_f32_16x16x32_bf16 v[168:171], a[188:191], a[236:239], v[168:171]
    v_mul_f32 v140, v140, v28
    v_mul_f32 v141, v141, v28
    v_mfma_f32_16x16x32_bf16 v[168:171], a[160:163], v[72:75], v[168:171]
    v_mul_f32 v142, v142, v28
    v_mul_f32 v143, v143, v28
    v_mfma_f32_16x16x32_bf16 v[168:171], a[164:167], v[84:87], v[168:171]
    buffer_load_dwordx4 v7, s[8:11], s25 offen offset:128 lds
    v_cvt_pk_bf16_f32 v140, v140, v141
    v_cvt_pk_bf16_f32 v141, v142, v143
    v_mfma_f32_16x16x32_bf16 v[180:183], a[252:255], v[84:87], v[180:183]
    s_mov_b32 m0, s70
    ds_write_b64 v33, v[140:141] offset:4096
    v_mfma_f32_16x16x32_bf16 v[180:183], a[248:251], v[72:75], v[180:183]
    ds_read_b128 v[104:107], v24 offset:4096
    ds_read_b128 v[116:119], v24 offset:5120
    v_mfma_f32_16x16x32_bf16 v[180:183], a[172:175], a[236:239], v[180:183]
    v_mul_f32 v144, v144, v26
    buffer_store_dwordx4 v[112:115], v23, s[16:19], s99 offen
    v_mul_f32 v145, v145, v26
    v_mul_f32 v146, v146, v26
    v_mul_f32 v147, v147, v26
    v_cvt_pk_bf16_f32 v144, v144, v145
    v_mfma_f32_16x16x32_bf16 v[180:183], a[168:171], a[224:227], v[180:183]
    ds_read_b64_tr_b16 a[96:97], v3 offset:2048
    ds_read_b64_tr_b16 a[98:99], v3 offset:10240
    v_mfma_f32_16x16x32_bf16 v[148:151], a[136:139], a[228:231], v[148:151]
    v_cvt_pk_bf16_f32 v145, v146, v147
    v_mul_f32 v156, v156, v26
    v_mfma_f32_16x16x32_bf16 v[148:151], a[140:143], a[240:243], v[148:151]
    buffer_load_dwordx4 v7, s[8:11], s25 offen offset:256 lds
    v_mfma_f32_16x16x32_bf16 v[148:151], a[144:147], v[76:79], v[148:151]
    s_mov_b32 m0, s71
    ds_write_b64 v30, v[144:145] offset:0
    v_mfma_f32_16x16x32_bf16 v[148:151], a[148:151], v[88:91], v[148:151]
    ds_read_b64_tr_b16 a[100:101], v3 offset:18432
    ds_read_b64_tr_b16 a[102:103], v3 offset:26624
    v_mfma_f32_16x16x32_bf16 v[160:163], a[180:183], v[88:91], v[160:163]
    ds_read_b64_tr_b16 a[104:105], v3 offset:34816
    ds_read_b64_tr_b16 a[106:107], v3 offset:43008
    v_mul_f32 v157, v157, v26
    v_mul_f32 v158, v158, v26
    v_mfma_f32_16x16x32_bf16 v[160:163], a[176:179], v[76:79], v[160:163]
    buffer_load_dwordx4 v7, s[8:11], s25 offen offset:384 lds
    v_mfma_f32_16x16x32_bf16 v[160:163], a[156:159], a[240:243], v[160:163]
    s_add_u32 s25, s25, 16384
    ds_read_b64_tr_b16 a[108:109], v3 offset:51200
    ds_read_b64_tr_b16 a[110:111], v3 offset:59392
    v_mul_f32 v159, v159, v26
    v_cvt_pk_bf16_f32 v156, v156, v157
    v_cvt_pk_bf16_f32 v157, v158, v159
    v_mfma_f32_16x16x32_bf16 v[160:163], a[152:155], a[228:231], v[160:163]
    s_and_b32 s25, s25, 0x3ffff
    ds_write_b64 v31, v[156:157] offset:0
    v_mfma_f32_16x16x32_bf16 v[172:175], a[184:187], a[228:231], v[172:175]
    s_mov_b32 m0, s72
    s_waitcnt lgkmcnt(5)
    buffer_store_dwordx4 v[104:107], v23, s[16:19], s100 offen
    ds_read_b64_tr_b16 a[112:113], v4 offset:2048
    ds_read_b64_tr_b16 a[114:115], v4 offset:10240
    ds_read_b64_tr_b16 a[116:117], v4 offset:18432
    ds_read_b64_tr_b16 a[118:119], v4 offset:26624
    v_mul_f32 v168, v168, v26
    v_mul_f32 v169, v169, v26
    v_mul_f32 v170, v170, v26
    v_mfma_f32_16x16x32_bf16 v[172:175], a[188:191], a[240:243], v[172:175]
    ds_read_b64_tr_b16 a[120:121], v4 offset:34816
    ds_read_b64_tr_b16 a[122:123], v4 offset:43008
    v_mul_f32 v171, v171, v26
    v_cvt_pk_bf16_f32 v168, v168, v169
    v_cvt_pk_bf16_f32 v169, v170, v171
    v_mfma_f32_16x16x32_bf16 v[172:175], a[160:163], v[76:79], v[172:175]
    ds_write_b64 v32, v[168:169] offset:0
    v_mfma_f32_16x16x32_bf16 v[172:175], a[164:167], v[88:91], v[172:175]
    ds_read_b64_tr_b16 a[124:125], v4 offset:51200
    ds_read_b64_tr_b16 a[126:127], v4 offset:59392
    v_mfma_f32_16x16x32_bf16 v[184:187], a[252:255], v[88:91], v[184:187]
    ds_read_b64_tr_b16 a[128:129], v5 offset:2048
    ds_read_b64_tr_b16 a[130:131], v5 offset:10240
    v_mul_f32 v180, v180, v26
    v_mul_f32 v181, v181, v26
    v_mul_f32 v182, v182, v26
    v_mfma_f32_16x16x32_bf16 v[184:187], a[248:251], v[76:79], v[184:187]
    ds_read_b64_tr_b16 a[132:133], v5 offset:18432
    ds_read_b64_tr_b16 a[134:135], v5 offset:26624
    v_mul_f32 v183, v183, v26
    v_cvt_pk_bf16_f32 v180, v180, v181
    v_cvt_pk_bf16_f32 v181, v182, v183
    v_mfma_f32_16x16x32_bf16 v[184:187], a[172:175], a[240:243], v[184:187]
    ds_write_b64 v33, v[180:181] offset:0
    v_mfma_f32_16x16x32_bf16 v[184:187], a[168:171], a[228:231], v[184:187]
    ds_read_b128 v[144:147], v24 offset:0
    ds_read_b128 v[156:159], v24 offset:1024
    v_mfma_f32_16x16x32_bf16 v[152:155], a[136:139], a[232:235], v[152:155]
    buffer_store_dwordx4 v[116:119], v23, s[16:19], s101 offen
    ds_read_b64_tr_b16 a[136:137], v5 offset:34816
    ds_read_b64_tr_b16 a[138:139], v5 offset:43008
    v_mul_f32 v148, v148, v27
    v_mul_f32 v149, v149, v27
    v_mfma_f32_16x16x32_bf16 v[152:155], a[140:143], a[244:247], v[152:155]
    ds_read_b64_tr_b16 a[140:141], v5 offset:51200
    ds_read_b64_tr_b16 a[142:143], v5 offset:59392
    v_mfma_f32_16x16x32_bf16 v[152:155], a[144:147], v[80:83], v[152:155]
    ds_read_b64_tr_b16 a[144:145], v6 offset:2048
    ds_read_b64_tr_b16 a[146:147], v6 offset:10240
    v_mul_f32 v150, v150, v27
    v_mul_f32 v151, v151, v27
    v_cvt_pk_bf16_f32 v148, v148, v149
    v_cvt_pk_bf16_f32 v149, v150, v151
    v_mfma_f32_16x16x32_bf16 v[152:155], a[148:151], v[92:95], v[152:155]
    s_waitcnt vmcnt(14)
    ds_write_b64 v30, v[148:149] offset:2048
    v_mfma_f32_16x16x32_bf16 v[164:167], a[180:183], v[92:95], v[164:167]
    ds_read_b128 a[64:67], v40 offset:32768
    ds_read_b128 a[68:71], v41 offset:32768
    v_mfma_f32_16x16x32_bf16 v[164:167], a[176:179], v[80:83], v[164:167]
    ds_read_b128 a[72:75], v40 offset:33792
    ds_read_b128 a[76:79], v41 offset:33792
    v_mfma_f32_16x16x32_bf16 v[164:167], a[156:159], a[244:247], v[164:167]
    ds_read_b128 a[80:83], v40 offset:34816
    ds_read_b128 a[84:87], v41 offset:34816
    v_mul_f32 v160, v160, v27
    v_mul_f32 v161, v161, v27
    v_mul_f32 v162, v162, v27
    v_mul_f32 v163, v163, v27
    v_cvt_pk_bf16_f32 v160, v160, v161
    v_cvt_pk_bf16_f32 v161, v162, v163
    v_mfma_f32_16x16x32_bf16 v[164:167], a[152:155], a[232:235], v[164:167]
    ds_write_b64 v31, v[160:161] offset:2048
    v_mfma_f32_16x16x32_bf16 v[176:179], a[184:187], a[232:235], v[176:179]
    s_waitcnt lgkmcnt(8)
    ds_read_b128 a[88:91], v40 offset:35840
    ds_read_b64_tr_b16 a[148:149], v6 offset:18432
    buffer_store_dwordx4 v[144:147], v23, s[16:19], s96 offen offset:128
    ds_read_b64_tr_b16 a[150:151], v6 offset:26624
    ds_read_b128 a[92:95], v41 offset:35840
    v_mul_f32 v172, v172, v27
    v_mul_f32 v173, v173, v27
    v_mfma_f32_16x16x32_bf16 v[176:179], a[188:191], a[244:247], v[176:179]
    ds_read_b64_tr_b16 a[152:153], v6 offset:34816
    ds_read_b64_tr_b16 a[154:155], v6 offset:43008
    v_mfma_f32_16x16x32_bf16 v[176:179], a[160:163], v[80:83], v[176:179]
    ds_read_b64_tr_b16 a[156:157], v6 offset:51200
    ds_read_b64_tr_b16 a[158:159], v6 offset:59392
    v_mul_f32 v174, v174, v27
    v_mul_f32 v175, v175, v27
    v_cvt_pk_bf16_f32 v172, v172, v173
    v_cvt_pk_bf16_f32 v173, v174, v175
    v_mfma_f32_16x16x32_bf16 v[176:179], a[164:167], v[92:95], v[176:179]
    ds_write_b64 v32, v[172:173] offset:2048
    v_mfma_f32_16x16x32_bf16 v[188:191], a[252:255], v[92:95], v[188:191]
    v_mul_f32 v184, v184, v27
    v_mul_f32 v185, v185, v27
    v_mfma_f32_16x16x32_bf16 v[188:191], a[248:251], v[80:83], v[188:191]
    v_mul_f32 v186, v186, v27
    v_mul_f32 v187, v187, v27
    v_mfma_f32_16x16x32_bf16 v[188:191], a[172:175], a[244:247], v[188:191]
    v_cvt_pk_bf16_f32 v184, v184, v185
    v_cvt_pk_bf16_f32 v185, v186, v187
    v_mfma_f32_16x16x32_bf16 v[188:191], a[168:171], a[232:235], v[188:191]
    ds_write_b64 v33, v[184:185] offset:2048
    v_mfma_f32_16x16x32_bf16 v[192:195], a[96:99], a[224:227], v[192:195]
    ds_read_b128 v[148:151], v24 offset:2048
    ds_read_b128 v[160:163], v24 offset:3072
    v_mfma_f32_16x16x32_bf16 v[192:195], a[100:103], a[236:239], v[192:195]
    s_waitcnt lgkmcnt(4)
    buffer_load_dwordx4 v7, s[8:11], s25 offen lds
    v_mfma_f32_16x16x32_bf16 v[192:195], a[104:107], v[72:75], v[192:195]
    s_mov_b32 m0, s73
    v_mul_f32 v152, v152, v28
    v_mul_f32 v153, v153, v28
    v_mfma_f32_16x16x32_bf16 v[192:195], a[108:111], v[84:87], v[192:195]
    v_mul_f32 v154, v154, v28
    v_mul_f32 v155, v155, v28
    v_cvt_pk_bf16_f32 v152, v152, v153
    v_cvt_pk_bf16_f32 v153, v154, v155
    v_mfma_f32_16x16x32_bf16 v[204:207], a[124:127], v[84:87], v[204:207]
    ds_write_b64 v30, v[152:153] offset:4096
    buffer_store_dwordx4 v[156:159], v23, s[16:19], s97 offen offset:128
    v_mul_f32 v164, v164, v28
    v_mul_f32 v165, v165, v28
    v_mul_f32 v166, v166, v28
    v_mul_f32 v167, v167, v28
    v_mfma_f32_16x16x32_bf16 v[204:207], a[120:123], v[72:75], v[204:207]
    v_cvt_pk_bf16_f32 v164, v164, v165
    v_cvt_pk_bf16_f32 v165, v166, v167
    v_mfma_f32_16x16x32_bf16 v[204:207], a[116:119], a[236:239], v[204:207]
    v_mul_f32 v176, v176, v28
    v_mul_f32 v177, v177, v28
    v_mfma_f32_16x16x32_bf16 v[204:207], a[112:115], a[224:227], v[204:207]
    v_mul_f32 v178, v178, v28
    v_mul_f32 v179, v179, v28
    v_mfma_f32_16x16x32_bf16 v[216:219], a[128:131], a[224:227], v[216:219]
    ds_write_b64 v31, v[164:165] offset:4096
    v_mfma_f32_16x16x32_bf16 v[216:219], a[132:135], a[236:239], v[216:219]
    buffer_load_dwordx4 v7, s[8:11], s25 offen offset:128 lds
    v_mfma_f32_16x16x32_bf16 v[216:219], a[136:139], v[72:75], v[216:219]
    s_mov_b32 m0, s74
    v_cvt_pk_bf16_f32 v176, v176, v177
    v_cvt_pk_bf16_f32 v177, v178, v179
    v_mfma_f32_16x16x32_bf16 v[216:219], a[140:143], v[84:87], v[216:219]
    v_mul_f32 v188, v188, v28
    v_mul_f32 v189, v189, v28
    v_mfma_f32_16x16x32_bf16 v[228:231], a[156:159], v[84:87], v[228:231]
    ds_write_b64 v32, v[176:177] offset:4096
    v_mfma_f32_16x16x32_bf16 v[228:231], a[152:155], v[72:75], v[228:231]
    buffer_load_dwordx4 v7, s[8:11], s25 offen offset:256 lds
    v_mfma_f32_16x16x32_bf16 v[228:231], a[148:151], a[236:239], v[228:231]
    s_mov_b32 m0, s75
    v_mul_f32 v190, v190, v28
    v_mul_f32 v191, v191, v28
    v_mfma_f32_16x16x32_bf16 v[228:231], a[144:147], a[224:227], v[228:231]
    v_cvt_pk_bf16_f32 v188, v188, v189
    v_cvt_pk_bf16_f32 v189, v190, v191
    v_mfma_f32_16x16x32_bf16 v[196:199], a[96:99], a[228:231], v[196:199]
    ds_write_b64 v33, v[188:189] offset:4096
    v_mfma_f32_16x16x32_bf16 v[196:199], a[100:103], a[240:243], v[196:199]
    s_waitcnt lgkmcnt(2)
    buffer_store_dwordx4 v[148:151], v23, s[16:19], s98 offen offset:128
    ds_read_b128 v[152:155], v24 offset:4096
    ds_read_b128 v[164:167], v24 offset:5120
    ds_read_b64_tr_b16 a[176:177], v3 offset:3072
    ds_read_b64_tr_b16 a[178:179], v3 offset:11264
    v_mfma_f32_16x16x32_bf16 v[196:199], a[104:107], v[76:79], v[196:199]
    ds_read_b64_tr_b16 a[180:181], v3 offset:19456
    ds_read_b64_tr_b16 a[182:183], v3 offset:27648
    v_mfma_f32_16x16x32_bf16 v[196:199], a[108:111], v[88:91], v[196:199]
    ds_read_b64_tr_b16 a[184:185], v3 offset:35840
    ds_read_b64_tr_b16 a[186:187], v3 offset:44032
    v_mfma_f32_16x16x32_bf16 v[208:211], a[124:127], v[88:91], v[208:211]
    buffer_load_dwordx4 v7, s[8:11], s25 offen offset:384 lds
    v_mul_f32 v192, v192, v26
    v_mul_f32 v193, v193, v26
    v_mul_f32 v194, v194, v26
    v_mul_f32 v195, v195, v26
    v_mfma_f32_16x16x32_bf16 v[208:211], a[120:123], v[76:79], v[208:211]
    s_add_u32 s25, s25, 16384
    ds_read_b64_tr_b16 a[188:189], v3 offset:52224
    ds_read_b64_tr_b16 a[190:191], v3 offset:60416
    v_cvt_pk_bf16_f32 v192, v192, v193
    v_cvt_pk_bf16_f32 v193, v194, v195
    v_mfma_f32_16x16x32_bf16 v[208:211], a[116:119], a[240:243], v[208:211]
    s_and_b32 s25, s25, 0x3ffff
    ds_write_b64 v30, v[192:193] offset:0
    v_mfma_f32_16x16x32_bf16 v[208:211], a[112:115], a[228:231], v[208:211]
    s_mov_b32 m0, s76
    ds_read_b64_tr_b16 a[160:161], v4 offset:3072
    v_mul_f32 v204, v204, v26
    v_mfma_f32_16x16x32_bf16 v[220:223], a[128:131], a[228:231], v[220:223]
    buffer_load_dwordx4 v7, s[8:11], s25 offen lds
    v_mfma_f32_16x16x32_bf16 v[220:223], a[132:135], a[240:243], v[220:223]
    s_mov_b32 m0, s77
    ds_read_b64_tr_b16 a[162:163], v4 offset:11264
    ds_read_b64_tr_b16 a[164:165], v4 offset:19456
    v_mfma_f32_16x16x32_bf16 v[220:223], a[136:139], v[76:79], v[220:223]
    ds_read_b64_tr_b16 a[166:167], v4 offset:27648
    v_mul_f32 v205, v205, v26
    v_mul_f32 v206, v206, v26
    v_mul_f32 v207, v207, v26
    v_cvt_pk_bf16_f32 v204, v204, v205
    v_cvt_pk_bf16_f32 v205, v206, v207
    v_mfma_f32_16x16x32_bf16 v[220:223], a[140:143], v[88:91], v[220:223]
    buffer_store_dwordx4 v[160:163], v23, s[16:19], s99 offen offset:128
    ds_write_b64 v31, v[204:205] offset:0
    ds_read_b64_tr_b16 a[168:169], v4 offset:35840
    v_mfma_f32_16x16x32_bf16 v[232:235], a[156:159], v[88:91], v[232:235]
    ds_read_b64_tr_b16 a[170:171], v4 offset:44032
    ds_read_b64_tr_b16 a[172:173], v4 offset:52224
    v_mfma_f32_16x16x32_bf16 v[232:235], a[152:155], v[76:79], v[232:235]
    ds_read_b64_tr_b16 a[174:175], v4 offset:60416
    ds_read_b64_tr_b16 a[248:249], v5 offset:3072
    v_mfma_f32_16x16x32_bf16 v[232:235], a[148:151], a[240:243], v[232:235]
    buffer_load_dwordx4 v7, s[8:11], s25 offen offset:128 lds
    v_mfma_f32_16x16x32_bf16 v[232:235], a[144:147], a[228:231], v[232:235]
    s_mov_b32 m0, s78
    ds_read_b64_tr_b16 a[250:251], v5 offset:11264
    v_mul_f32 v216, v216, v26
    v_mul_f32 v217, v217, v26
    v_mul_f32 v218, v218, v26
    v_mul_f32 v219, v219, v26
    v_cvt_pk_bf16_f32 v216, v216, v217
    v_cvt_pk_bf16_f32 v217, v218, v219
    v_mfma_f32_16x16x32_bf16 v[200:203], a[96:99], a[232:235], v[200:203]
    ds_write_b64 v32, v[216:217] offset:0
    v_mfma_f32_16x16x32_bf16 v[200:203], a[100:103], a[244:247], v[200:203]
    buffer_load_dwordx4 v7, s[8:11], s25 offen offset:256 lds
    v_mfma_f32_16x16x32_bf16 v[200:203], a[104:107], v[80:83], v[200:203]
    s_mov_b32 m0, s79
    ds_read_b64_tr_b16 a[252:253], v5 offset:19456
    ds_read_b64_tr_b16 a[254:255], v5 offset:27648
    v_mfma_f32_16x16x32_bf16 v[200:203], a[108:111], v[92:95], v[200:203]
    ds_read_b64_tr_b16 a[96:97], v5 offset:35840
    ds_read_b64_tr_b16 a[98:99], v5 offset:44032
    v_mfma_f32_16x16x32_bf16 v[212:215], a[124:127], v[92:95], v[212:215]
    s_waitcnt lgkmcnt(6)
    ds_read_b64_tr_b16 a[100:101], v5 offset:52224
    ds_read_b64_tr_b16 a[102:103], v5 offset:60416
    v_mul_f32 v228, v228, v26
    v_mul_f32 v229, v229, v26
    buffer_store_dwordx4 v[152:155], v23, s[16:19], s100 offen offset:128
    v_mul_f32 v230, v230, v26
    v_mul_f32 v231, v231, v26
    v_cvt_pk_bf16_f32 v228, v228, v229
    v_cvt_pk_bf16_f32 v229, v230, v231
    v_mfma_f32_16x16x32_bf16 v[212:215], a[120:123], v[80:83], v[212:215]
    ds_write_b64 v33, v[228:229] offset:0
    ds_read_b128 v[192:195], v24 offset:0
    ds_read_b128 v[204:207], v24 offset:1024
    v_mfma_f32_16x16x32_bf16 v[212:215], a[116:119], a[244:247], v[212:215]
    ds_read_b64_tr_b16 a[104:105], v6 offset:3072
    buffer_load_dwordx4 v7, s[8:11], s25 offen offset:384 lds
    v_mfma_f32_16x16x32_bf16 v[212:215], a[112:115], a[232:235], v[212:215]
    s_add_u32 s25, s25, 16384
    ds_read_b64_tr_b16 a[106:107], v6 offset:11264
    ds_read_b64_tr_b16 a[108:109], v6 offset:19456
    v_mfma_f32_16x16x32_bf16 v[224:227], a[128:131], a[232:235], v[224:227]
    s_and_b32 s25, s25, 0x3ffff
    ds_read_b64_tr_b16 a[110:111], v6 offset:27648
    ds_read_b64_tr_b16 a[112:113], v6 offset:35840
    v_mfma_f32_16x16x32_bf16 v[224:227], a[132:135], a[244:247], v[224:227]
    s_add_u32 s50, s50, 16777216
    ds_read_b64_tr_b16 a[114:115], v6 offset:44032
    ds_read_b64_tr_b16 a[116:117], v6 offset:52224
    v_mfma_f32_16x16x32_bf16 v[224:227], a[136:139], v[80:83], v[224:227]
    s_addc_u32 s51, s51, 0
    ds_read_b64_tr_b16 a[118:119], v6 offset:60416
    v_mul_f32 v196, v196, v27
    v_mul_f32 v197, v197, v27
    v_mul_f32 v198, v198, v27
    v_mul_f32 v199, v199, v27
    v_cvt_pk_bf16_f32 v196, v196, v197
    v_cvt_pk_bf16_f32 v197, v198, v199
    s_add_u32 s52, s52, 16777216
    s_addc_u32 s53, s53, 0
    s_mov_b32 s12, s52
    s_mov_b32 s13, s53
    s_cmp_eq_u32 s28, 0
    s_cselect_b32 s54, 0, 0
    s_add_u32 s32, s31, 25165824
    s_mov_b32 s41, s32
    s_cmp_eq_u32 s28, 0
    s_cselect_b32 s45, 16777216, 0
    s_cselect_b32 s34, 0, 0
    buffer_store_dwordx4 v[164:167], v23, s[16:19], s101 offen offset:128
    s_add_u32 s20, s50, s45
    s_addc_u32 s21, s51, 0
    ds_write_b64 v30, v[196:197] offset:2048
    v_mul_f32 v208, v208, v27
    v_mul_f32 v209, v209, v27
    v_mul_f32 v210, v210, v27
    v_mul_f32 v211, v211, v27
    v_cvt_pk_bf16_f32 v208, v208, v209
    v_cvt_pk_bf16_f32 v209, v210, v211
    v_mfma_f32_16x16x32_bf16 v[224:227], a[140:143], v[92:95], v[224:227]
    s_mov_b32 m0, s80
    ds_write_b64 v31, v[208:209] offset:2048
    v_mfma_f32_16x16x32_bf16 v[236:239], a[156:159], v[92:95], v[236:239]
    v_mul_f32 v220, v220, v27
    v_mul_f32 v221, v221, v27
    v_mfma_f32_16x16x32_bf16 v[236:239], a[152:155], v[80:83], v[236:239]
    v_mul_f32 v222, v222, v27
    v_mul_f32 v223, v223, v27
    v_mfma_f32_16x16x32_bf16 v[236:239], a[148:151], a[244:247], v[236:239]
    v_cvt_pk_bf16_f32 v220, v220, v221
    v_cvt_pk_bf16_f32 v221, v222, v223
    v_mfma_f32_16x16x32_bf16 v[236:239], a[144:147], a[232:235], v[236:239]
    ds_write_b64 v32, v[220:221] offset:2048
    v_mfma_f32_16x16x32_bf16 v[240:243], a[176:179], a[224:227], v[240:243]
    v_mul_f32 v232, v232, v27
    v_mul_f32 v233, v233, v27
    v_mfma_f32_16x16x32_bf16 v[240:243], a[180:183], a[236:239], v[240:243]
    v_mul_f32 v234, v234, v27
    v_mul_f32 v235, v235, v27
    v_mfma_f32_16x16x32_bf16 v[240:243], a[184:187], v[72:75], v[240:243]
    v_cvt_pk_bf16_f32 v232, v232, v233
    v_cvt_pk_bf16_f32 v233, v234, v235
    v_mfma_f32_16x16x32_bf16 v[240:243], a[188:191], v[84:87], v[240:243]
    s_waitcnt lgkmcnt(1)
    ds_write_b64 v33, v[232:233] offset:2048
    buffer_store_dwordx4 v[192:195], v23, s[16:19], s96 offen offset:256
    ds_read_b128 v[196:199], v24 offset:2048
    ds_read_b128 v[208:211], v24 offset:3072
    v_mov_b32 v14, 0
    v_mov_b32 v15, 0
    v_mfma_f32_16x16x32_bf16 v[252:255], a[172:175], v[84:87], v[252:255]
    v_mov_b32 v16, 0
    v_mul_f32 v200, v200, v28
    v_mfma_f32_16x16x32_bf16 v[252:255], a[168:171], v[72:75], v[252:255]
    v_mul_f32 v201, v201, v28
    v_mul_f32 v202, v202, v28
    v_mfma_f32_16x16x32_bf16 v[252:255], a[164:167], a[236:239], v[252:255]
    v_mul_f32 v203, v203, v28
    v_cvt_pk_bf16_f32 v200, v200, v201
    v_mfma_f32_16x16x32_bf16 v[252:255], a[160:163], a[224:227], v[252:255]
    v_cvt_pk_bf16_f32 v201, v202, v203
    v_mul_f32 v212, v212, v28
    v_mfma_f32_16x16x32_bf16 a[200:203], a[248:251], a[224:227], a[200:203]
    ds_write_b64 v30, v[200:201] offset:4096
    v_mfma_f32_16x16x32_bf16 a[200:203], a[252:255], a[236:239], a[200:203]
    v_mul_f32 v213, v213, v28
    v_mul_f32 v214, v214, v28
    v_mfma_f32_16x16x32_bf16 a[200:203], a[96:99], v[72:75], a[200:203]
    v_mul_f32 v215, v215, v28
    v_cvt_pk_bf16_f32 v212, v212, v213
    v_mfma_f32_16x16x32_bf16 a[200:203], a[100:103], v[84:87], a[200:203]
    v_cvt_pk_bf16_f32 v213, v214, v215
    v_mul_f32 v224, v224, v28
    v_mfma_f32_16x16x32_bf16 a[212:215], a[116:119], v[84:87], a[212:215]
    ds_write_b64 v31, v[212:213] offset:4096
    v_mfma_f32_16x16x32_bf16 a[212:215], a[112:115], v[72:75], a[212:215]
    v_mul_f32 v225, v225, v28
    v_mul_f32 v226, v226, v28
    v_mfma_f32_16x16x32_bf16 a[212:215], a[108:111], a[236:239], a[212:215]
    buffer_store_dwordx4 v[204:207], v23, s[16:19], s97 offen offset:256
    v_mul_f32 v227, v227, v28
    v_cvt_pk_bf16_f32 v224, v224, v225
    v_cvt_pk_bf16_f32 v225, v226, v227
    v_mul_f32 v236, v236, v28
    v_mfma_f32_16x16x32_bf16 a[212:215], a[104:107], a[224:227], a[212:215]
    v_mul_f32 v237, v237, v28
    v_mul_f32 v238, v238, v28
    v_mfma_f32_16x16x32_bf16 v[244:247], a[176:179], a[228:231], v[244:247]
    ds_write_b64 v32, v[224:225] offset:4096
    v_mfma_f32_16x16x32_bf16 v[244:247], a[180:183], a[240:243], v[244:247]
    v_mul_f32 v239, v239, v28
    v_cvt_pk_bf16_f32 v236, v236, v237
    v_mfma_f32_16x16x32_bf16 v[244:247], a[184:187], v[76:79], v[244:247]
    v_cvt_pk_bf16_f32 v237, v238, v239
    v_mfma_f32_16x16x32_bf16 v[244:247], a[188:191], v[88:91], v[244:247]
    v_mul_f32 v240, v240, v26
    v_mfma_f32_16x16x32_bf16 a[192:195], a[172:175], v[88:91], a[192:195]
    ds_write_b64 v33, v[236:237] offset:4096
    v_mfma_f32_16x16x32_bf16 a[192:195], a[168:171], v[76:79], a[192:195]
    ds_read_b128 v[200:203], v24 offset:4096
    ds_read_b128 v[212:215], v24 offset:5120
    v_mfma_f32_16x16x32_bf16 a[192:195], a[164:167], a[240:243], a[192:195]
    v_mul_f32 v241, v241, v26
    v_mul_f32 v242, v242, v26
    v_mfma_f32_16x16x32_bf16 a[192:195], a[160:163], a[228:231], a[192:195]
    v_mul_f32 v243, v243, v26
    v_cvt_pk_bf16_f32 v240, v240, v241
    v_mfma_f32_16x16x32_bf16 a[204:207], a[248:251], a[228:231], a[204:207]
    v_cvt_pk_bf16_f32 v241, v242, v243
    v_mul_f32 v252, v252, v26
    v_mfma_f32_16x16x32_bf16 a[204:207], a[252:255], a[240:243], a[204:207]
    s_waitcnt lgkmcnt(3)
    buffer_store_dwordx4 v[196:199], v23, s[16:19], s98 offen offset:256
    ds_write_b64 v30, v[240:241] offset:0
    v_mul_f32 v253, v253, v26
    v_mfma_f32_16x16x32_bf16 a[204:207], a[96:99], v[76:79], a[204:207]
    v_mul_f32 v254, v254, v26
    v_mul_f32 v255, v255, v26
    v_mfma_f32_16x16x32_bf16 a[204:207], a[100:103], v[88:91], a[204:207]
    v_cvt_pk_bf16_f32 v252, v252, v253
    v_cvt_pk_bf16_f32 v253, v254, v255
    v_mfma_f32_16x16x32_bf16 a[216:219], a[116:119], v[88:91], a[216:219]
    v_accvgpr_read_b32 v128, a200
    v_accvgpr_read_b32 v129, a201
    v_mfma_f32_16x16x32_bf16 a[216:219], a[112:115], v[76:79], a[216:219]
    ds_write_b64 v31, v[252:253] offset:0
    v_mfma_f32_16x16x32_bf16 a[216:219], a[108:111], a[240:243], a[216:219]
    v_accvgpr_read_b32 v130, a202
    v_accvgpr_read_b32 v131, a203
    v_mfma_f32_16x16x32_bf16 a[216:219], a[104:107], a[228:231], a[216:219]
    v_mul_f32 v128, v128, v26
    v_mul_f32 v129, v129, v26
    v_mfma_f32_16x16x32_bf16 v[248:251], a[176:179], a[232:235], v[248:251]
    v_mul_f32 v130, v130, v26
    v_mul_f32 v131, v131, v26
    v_mfma_f32_16x16x32_bf16 v[248:251], a[180:183], a[244:247], v[248:251]
    v_cvt_pk_bf16_f32 v128, v128, v129
    v_cvt_pk_bf16_f32 v129, v130, v131
    v_mfma_f32_16x16x32_bf16 v[248:251], a[184:187], v[80:83], v[248:251]
    ds_write_b64 v32, v[128:129] offset:0
    v_mfma_f32_16x16x32_bf16 v[248:251], a[188:191], v[92:95], v[248:251]
    v_accvgpr_read_b32 v140, a212
    v_accvgpr_read_b32 v141, a213
    v_mfma_f32_16x16x32_bf16 a[208:211], a[248:251], a[232:235], a[208:211]
    buffer_store_dwordx4 v[208:211], v23, s[16:19], s99 offen offset:256
    s_waitcnt vmcnt(26)
    s_barrier
    ds_read_b128 a[120:123], v1 offset:3072
    ds_read_b128 a[124:127], v2 offset:3072
    v_mfma_f32_16x16x32_bf16 a[208:211], a[252:255], a[244:247], a[208:211]
    ds_read_b128 a[128:131], v1 offset:8192
    ds_read_b128 a[132:135], v2 offset:8192
    v_mfma_f32_16x16x32_bf16 a[208:211], a[96:99], v[80:83], a[208:211]
    ds_read_b128 a[96:99], v1 offset:0
    ds_read_b128 a[136:139], v1 offset:9216
    v_mfma_f32_16x16x32_bf16 a[196:199], a[172:175], v[92:95], a[196:199]
    buffer_load_dwordx4 v7, s[12:15], s26 offen lds
    s_mov_b32 m0, s81
    v_accvgpr_read_b32 v142, a214
    v_mfma_f32_16x16x32_bf16 a[208:211], a[100:103], v[92:95], a[208:211]
    ds_read_b128 a[100:103], v2 offset:0
    v_accvgpr_read_b32 v143, a215
    v_mul_f32 v140, v140, v26
    v_mfma_f32_16x16x32_bf16 a[196:199], a[168:171], v[80:83], a[196:199]
    v_mul_f32 v141, v141, v26
    v_mul_f32 v142, v142, v26
    v_mul_f32 v143, v143, v26
    v_mfma_f32_16x16x32_bf16 a[220:223], a[116:119], v[92:95], a[220:223]
    buffer_load_dwordx4 v7, s[12:15], s26 offen offset:128 lds
    s_mov_b32 m0, s82
    v_mfma_f32_16x16x32_bf16 a[220:223], a[112:115], v[80:83], a[220:223]
    ds_read_b128 a[112:115], v1 offset:2048
    ds_read_b128 a[116:119], v2 offset:2048
    v_mfma_f32_16x16x32_bf16 a[220:223], a[108:111], a[244:247], a[220:223]
    ds_read_b128 a[108:111], v2 offset:1024
    ds_read_b128 a[140:143], v2 offset:9216
    v_mfma_f32_16x16x32_bf16 a[220:223], a[104:107], a[232:235], a[220:223]
    ds_read_b128 a[104:107], v1 offset:1024
    v_cvt_pk_bf16_f32 v140, v140, v141
    v_cvt_pk_bf16_f32 v141, v142, v143
    buffer_load_dwordx4 v7, s[12:15], s26 offen offset:256 lds
    s_mov_b32 m0, s83
    ds_write_b64 v33, v[140:141] offset:0
    v_mfma_f32_16x16x32_bf16 a[196:199], a[164:167], a[244:247], a[196:199]
    ds_read_b128 v[240:243], v24 offset:0
    ds_read_b128 v[252:255], v24 offset:1024
    v_mfma_f32_16x16x32_bf16 a[196:199], a[160:163], a[232:235], a[196:199]
    s_waitcnt lgkmcnt(8)
    ds_read_b128 a[144:147], v1 offset:10240
    ds_read_b128 a[148:151], v2 offset:10240
    v_mul_f32 v244, v244, v27
    v_mul_f32 v245, v245, v27
    buffer_store_dwordx4 v[200:203], v23, s[16:19], s100 offen offset:256
    ds_read_b128 a[152:155], v1 offset:11264
    ds_read_b128 a[156:159], v2 offset:11264
    v_mul_f32 v246, v246, v27
    v_mul_f32 v247, v247, v27
    v_cvt_pk_bf16_f32 v244, v244, v245
    v_cvt_pk_bf16_f32 v245, v246, v247
    v_accvgpr_read_b32 v120, a192
    v_accvgpr_read_b32 v121, a193
    v_accvgpr_read_b32 v122, a194
    v_accvgpr_read_b32 v123, a195
    v_mul_f32 v120, v120, v27
    v_mul_f32 v121, v121, v27
    v_mul_f32 v122, v122, v27
    v_mul_f32 v123, v123, v27
    buffer_load_dwordx4 v7, s[12:15], s26 offen offset:384 lds
    s_add_u32 s26, s26, 16384
    s_mov_b32 m0, s84
    s_and_b32 s26, s26, 0x3ffff
    ds_write_b64 v30, v[244:245] offset:2048
    v_cvt_pk_bf16_f32 v120, v120, v121
    v_cvt_pk_bf16_f32 v121, v122, v123
    v_mfma_f32_16x16x32_bf16 v[48:51], a[96:99], a[0:3], 0
    ds_write_b64 v31, v[120:121] offset:2048
    v_mfma_f32_16x16x32_bf16 v[48:51], a[100:103], a[4:7], v[48:51]
    s_waitcnt lgkmcnt(2)
    buffer_load_dwordx4 v7, s[12:15], s26 offen lds
    s_mov_b32 m0, s85
    v_accvgpr_read_b32 v132, a204
    v_mfma_f32_16x16x32_bf16 v[48:51], a[104:107], a[8:11], v[48:51]
    v_accvgpr_read_b32 v133, a205
    v_accvgpr_read_b32 v134, a206
    v_accvgpr_read_b32 v135, a207
    v_mul_f32 v132, v132, v27
    v_mul_f32 v133, v133, v27
    v_mul_f32 v134, v134, v27
    v_mul_f32 v135, v135, v27
    v_mfma_f32_16x16x32_bf16 v[48:51], a[108:111], a[12:15], v[48:51]
    v_cvt_pk_bf16_f32 v132, v132, v133
    buffer_store_dwordx4 v[212:215], v23, s[16:19], s101 offen offset:256
    v_cvt_pk_bf16_f32 v133, v134, v135
    v_accvgpr_read_b32 v168, a216
    v_accvgpr_read_b32 v169, a217
    v_accvgpr_read_b32 v170, a218
    v_mfma_f32_16x16x32_bf16 v[48:51], a[112:115], a[16:19], v[48:51]
    ds_write_b64 v32, v[132:133] offset:2048
    v_mfma_f32_16x16x32_bf16 v[48:51], a[116:119], a[20:23], v[48:51]
    v_accvgpr_read_b32 v171, a219
    v_mul_f32 v168, v168, v27
    v_mfma_f32_16x16x32_bf16 v[48:51], a[120:123], a[24:27], v[48:51]
    buffer_load_dwordx4 v7, s[12:15], s26 offen offset:128 lds
    s_mov_b32 m0, s86
    v_mfma_f32_16x16x32_bf16 v[48:51], a[124:127], a[28:31], v[48:51]
    v_mul_f32 v169, v169, v27
    v_mul_f32 v170, v170, v27
    v_mul_f32 v171, v171, v27
    v_cvt_pk_bf16_f32 v168, v168, v169
    v_cvt_pk_bf16_f32 v169, v170, v171
    v_mfma_f32_16x16x32_bf16 v[60:63], a[156:159], a[28:31], 0
    ds_write_b64 v33, v[168:169] offset:2048
    v_mfma_f32_16x16x32_bf16 v[60:63], a[152:155], a[24:27], v[60:63]
    buffer_load_dwordx4 v7, s[12:15], s26 offen offset:256 lds
    s_mov_b32 m0, s87
    ds_read_b128 v[244:247], v24 offset:2048
    ds_read_b128 v[232:235], v24 offset:3072
    v_mfma_f32_16x16x32_bf16 v[60:63], a[148:151], a[20:23], v[60:63]
    v_mul_f32 v248, v248, v28
    v_mul_f32 v249, v249, v28
    v_mfma_f32_16x16x32_bf16 v[60:63], a[144:147], a[16:19], v[60:63]
    v_mul_f32 v250, v250, v28
    v_mul_f32 v251, v251, v28
    v_mfma_f32_16x16x32_bf16 v[60:63], a[140:143], a[12:15], v[60:63]
    v_cvt_pk_bf16_f32 v248, v248, v249
    buffer_load_dwordx4 v7, s[12:15], s26 offen offset:384 lds
    s_add_u32 s26, s26, 16384
    s_mov_b32 m0, s88
    s_and_b32 s26, s26, 0x3ffff
    v_mfma_f32_16x16x32_bf16 v[60:63], a[136:139], a[8:11], v[60:63]
    v_cvt_pk_bf16_f32 v249, v250, v251
    v_accvgpr_read_b32 v124, a196
    v_mfma_f32_16x16x32_bf16 v[60:63], a[132:135], a[4:7], v[60:63]
    ds_write_b64 v30, v[248:249] offset:4096
    v_mfma_f32_16x16x32_bf16 v[60:63], a[128:131], a[0:3], v[60:63]
    buffer_store_dwordx4 v[240:243], v23, s[16:19], s96 offen offset:384
    v_accvgpr_read_b32 v125, a197
    v_accvgpr_read_b32 v126, a198
    v_accvgpr_read_b32 v127, a199
    v_mul_f32 v124, v124, v28
    v_mul_f32 v125, v125, v28
    v_mul_f32 v126, v126, v28
    v_mul_f32 v127, v127, v28
    v_cvt_pk_bf16_f32 v124, v124, v125
    v_cvt_pk_bf16_f32 v125, v126, v127
    v_mfma_f32_16x16x32_bf16 v[52:55], a[96:99], a[32:35], 0
    ds_write_b64 v31, v[124:125] offset:4096
    buffer_load_dwordx4 v7, s[12:15], s26 offen lds
    s_mov_b32 m0, s89
    v_mfma_f32_16x16x32_bf16 v[52:55], a[100:103], a[36:39], v[52:55]
    v_accvgpr_read_b32 v136, a208
    v_accvgpr_read_b32 v137, a209
    v_mfma_f32_16x16x32_bf16 v[52:55], a[104:107], a[40:43], v[52:55]
    v_accvgpr_read_b32 v138, a210
    v_accvgpr_read_b32 v139, a211
    v_mfma_f32_16x16x32_bf16 v[52:55], a[108:111], a[44:47], v[52:55]
    v_mul_f32 v136, v136, v28
    v_mul_f32 v137, v137, v28
    v_mul_f32 v138, v138, v28
    buffer_load_dwordx4 v7, s[12:15], s26 offen offset:128 lds
    s_mov_b32 m0, s90
    v_mul_f32 v139, v139, v28
    v_cvt_pk_bf16_f32 v136, v136, v137
    v_max3_f32 v34, v48, v49, v50
    v_max3_f32 v35, v51, v60, v61
    v_max3_f32 v34, v34, v62, v63
    v_max_f32 v34, v34, v35
    v_mov_b32 v35, v34
    v_cvt_pk_bf16_f32 v137, v138, v139
    v_mfma_f32_16x16x32_bf16 v[52:55], a[112:115], a[48:51], v[52:55]
    ds_write_b64 v32, v[136:137] offset:4096
    buffer_store_dwordx4 v[252:255], v23, s[16:19], s97 offen offset:384
    v_permlane32_swap_b32 v34, v35
    v_max_f32 v34, v34, v35
    v_mov_b32 v35, v34
    v_mfma_f32_16x16x32_bf16 v[52:55], a[116:119], a[52:55], v[52:55]
    v_accvgpr_read_b32 v172, a220
    v_permlane16_swap_b32 v34, v35
    v_max_f32 v34, v34, v35
    v_mul_f32 v34, s30, v34
    v_cndmask_b32 v8, v34, v8, s[42:43]
    v_mfma_f32_16x16x32_bf16 v[52:55], a[120:123], a[56:59], v[52:55]
    buffer_load_dwordx4 v7, s[12:15], s26 offen offset:256 lds
    s_mov_b32 m0, s91
    v_mfma_f32_16x16x32_bf16 v[52:55], a[124:127], a[60:63], v[52:55]
    v_accvgpr_read_b32 v173, a221
    v_accvgpr_read_b32 v174, a222
    v_fma_f32 v48, v48, s29, v8
    v_accvgpr_read_b32 v175, a223
    v_mul_f32 v172, v172, v28
    v_mul_f32 v173, v173, v28
    v_mfma_f32_16x16x32_bf16 v[64:67], a[156:159], a[60:63], 0
    v_mul_f32 v174, v174, v28
    v_fma_f32 v49, v49, s29, v8
    v_mul_f32 v175, v175, v28
    buffer_load_dwordx4 v7, s[12:15], s26 offen offset:384 lds
    s_add_u32 s26, s26, 16384
    s_and_b32 s26, s26, 0x3ffff
    v_cvt_pk_bf16_f32 v172, v172, v173
    v_cvt_pk_bf16_f32 v173, v174, v175
    v_fma_f32 v50, v50, s29, v8
    v_mfma_f32_16x16x32_bf16 v[64:67], a[152:155], a[56:59], v[64:67]
    ds_write_b64 v33, v[172:173] offset:4096
    v_mfma_f32_16x16x32_bf16 v[64:67], a[148:151], a[52:55], v[64:67]
    ds_read_b128 v[248:251], v24 offset:4096
    ds_read_b128 v[236:239], v24 offset:5120
    v_fma_f32 v51, v51, s29, v8
    v_exp_f32 v48, v48
    v_exp_f32 v49, v49
    v_exp_f32 v50, v50
    v_mfma_f32_16x16x32_bf16 v[64:67], a[144:147], a[48:51], v[64:67]
    v_exp_f32 v51, v51
    v_cvt_pk_bf16_f32 v72, v48, v49
    v_mfma_f32_16x16x32_bf16 v[64:67], a[140:143], a[44:47], v[64:67]
    v_add_f32 v14, v14, v48
    v_add_f32 v14, v14, v49
    v_mfma_f32_16x16x32_bf16 v[64:67], a[136:139], a[40:43], v[64:67]
    v_cvt_pk_bf16_f32 v73, v50, v51
    v_add_f32 v14, v14, v50
    v_mfma_f32_16x16x32_bf16 v[64:67], a[132:135], a[36:39], v[64:67]
    v_add_f32 v14, v14, v51
    v_fma_f32 v60, v60, s29, v8
    v_mfma_f32_16x16x32_bf16 v[64:67], a[128:131], a[32:35], v[64:67]
    v_fma_f32 v61, v61, s29, v8
    v_fma_f32 v62, v62, s29, v8
    v_fma_f32 v63, v63, s29, v8
    v_exp_f32 v60, v60
    v_exp_f32 v61, v61
    v_exp_f32 v62, v62
    v_exp_f32 v63, v63
    v_cvt_pk_bf16_f32 v74, v60, v61
    v_add_f32 v14, v14, v60
    v_add_f32 v14, v14, v61
    v_mfma_f32_16x16x32_bf16 v[56:59], a[96:99], a[64:67], 0
    v_cvt_pk_bf16_f32 v75, v62, v63
    v_add_f32 v14, v14, v62
    v_mfma_f32_16x16x32_bf16 v[56:59], a[100:103], a[68:71], v[56:59]
    v_add_f32 v14, v14, v63
    v_max3_f32 v36, v52, v53, v54
    v_mfma_f32_16x16x32_bf16 v[56:59], a[104:107], a[72:75], v[56:59]
    v_max3_f32 v37, v55, v64, v65
    v_max3_f32 v36, v36, v66, v67
    v_mfma_f32_16x16x32_bf16 v[56:59], a[108:111], a[76:79], v[56:59]
    v_max_f32 v36, v36, v37
    v_mov_b32 v37, v36
    v_mfma_f32_16x16x32_bf16 v[56:59], a[112:115], a[80:83], v[56:59]
    s_nop 0
    v_permlane32_swap_b32 v36, v37
    v_max_f32 v36, v36, v37
    v_mov_b32 v37, v36
    v_mfma_f32_16x16x32_bf16 v[56:59], a[116:119], a[84:87], v[56:59]
    s_nop 0
    v_permlane16_swap_b32 v36, v37
    v_max_f32 v36, v36, v37
    v_mul_f32 v36, s30, v36
    v_cndmask_b32 v9, v36, v9, s[42:43]
    v_mfma_f32_16x16x32_bf16 v[56:59], a[120:123], a[88:91], v[56:59]
    v_fma_f32 v52, v52, s29, v9
    v_fma_f32 v53, v53, s29, v9
    v_mfma_f32_16x16x32_bf16 v[56:59], a[124:127], a[92:95], v[56:59]
    v_fma_f32 v54, v54, s29, v9
    v_fma_f32 v55, v55, s29, v9
    v_mfma_f32_16x16x32_bf16 v[68:71], a[156:159], a[92:95], 0
    v_exp_f32 v52, v52
    v_mfma_f32_16x16x32_bf16 v[68:71], a[152:155], a[88:91], v[68:71]
    v_exp_f32 v53, v53
    v_mfma_f32_16x16x32_bf16 v[68:71], a[148:151], a[84:87], v[68:71]
    v_exp_f32 v54, v54
    v_mfma_f32_16x16x32_bf16 v[68:71], a[144:147], a[80:83], v[68:71]
    v_exp_f32 v55, v55
    v_cvt_pk_bf16_f32 v76, v52, v53
    v_mfma_f32_16x16x32_bf16 v[68:71], a[140:143], a[76:79], v[68:71]
    v_add_f32 v15, v15, v52
    v_add_f32 v15, v15, v53
    v_mfma_f32_16x16x32_bf16 v[68:71], a[136:139], a[72:75], v[68:71]
    v_cvt_pk_bf16_f32 v77, v54, v55
    v_add_f32 v15, v15, v54
    v_mfma_f32_16x16x32_bf16 v[68:71], a[132:135], a[68:71], v[68:71]
    v_add_f32 v15, v15, v55
    v_fma_f32 v64, v64, s29, v9
    v_mfma_f32_16x16x32_bf16 v[68:71], a[128:131], a[64:67], v[68:71]
    v_fma_f32 v65, v65, s29, v9
    v_fma_f32 v66, v66, s29, v9
    v_fma_f32 v67, v67, s29, v9
    v_exp_f32 v64, v64
    v_exp_f32 v65, v65
    v_exp_f32 v66, v66
    v_exp_f32 v67, v67
    v_cvt_pk_bf16_f32 v78, v64, v65
    v_add_f32 v15, v15, v64
    v_add_f32 v15, v15, v65
    v_cvt_pk_bf16_f32 v79, v66, v67
    v_add_f32 v15, v15, v66
    v_add_f32 v15, v15, v67
    v_max3_f32 v38, v56, v57, v58
    v_max3_f32 v39, v59, v68, v69
    v_max3_f32 v38, v38, v70, v71
    v_max_f32 v38, v38, v39
    v_mov_b32 v39, v38
    s_nop 1
    v_permlane32_swap_b32 v38, v39
    v_max_f32 v38, v38, v39
    v_mov_b32 v39, v38
    s_nop 1
    v_permlane16_swap_b32 v38, v39
    v_max_f32 v38, v38, v39
    v_mul_f32 v38, s30, v38
    v_cndmask_b32 v10, v38, v10, s[42:43]
    v_fma_f32 v56, v56, s29, v10
    v_fma_f32 v57, v57, s29, v10
    v_fma_f32 v58, v58, s29, v10
    v_fma_f32 v59, v59, s29, v10
    v_exp_f32 v56, v56
    v_exp_f32 v57, v57
    v_exp_f32 v58, v58
    v_exp_f32 v59, v59
    v_cvt_pk_bf16_f32 v80, v56, v57
    s_waitcnt vmcnt(11)
    s_barrier
    ds_read_b128 a[96:99], v1 offset:16384
    ds_read_b128 a[100:103], v2 offset:16384
    ds_read_b128 a[104:107], v1 offset:17408
    ds_read_b128 a[108:111], v2 offset:17408
    ds_read_b128 a[112:115], v1 offset:18432
    v_add_f32 v16, v16, v56
    v_add_f32 v16, v16, v57
    v_cvt_pk_bf16_f32 v81, v58, v59
    v_add_f32 v16, v16, v58
    v_add_f32 v16, v16, v59
    v_fma_f32 v68, v68, s29, v10
    v_fma_f32 v69, v69, s29, v10
    v_fma_f32 v70, v70, s29, v10
    v_fma_f32 v71, v71, s29, v10
    v_exp_f32 v68, v68
    v_exp_f32 v69, v69
    v_exp_f32 v70, v70
    ds_read_b128 a[116:119], v2 offset:18432
    ds_read_b128 a[120:123], v1 offset:19456
    ds_read_b128 a[124:127], v2 offset:19456
    v_exp_f32 v71, v71
    v_cvt_pk_bf16_f32 v82, v68, v69
    v_add_f32 v16, v16, v68
    v_add_f32 v16, v16, v69
    v_cvt_pk_bf16_f32 v83, v70, v71
    v_add_f32 v16, v16, v70
    v_add_f32 v16, v16, v71
    s_waitcnt lgkmcnt(0)
    v_mfma_f32_16x16x32_bf16 v[48:51], a[96:99], a[0:3], 0
    s_mov_b32 m0, s64
    ds_read_b128 a[128:131], v1 offset:24576
    v_mfma_f32_16x16x32_bf16 v[48:51], a[100:103], a[4:7], v[48:51]
    buffer_load_dwordx4 v7, s[8:11], s25 offen lds
    v_mfma_f32_16x16x32_bf16 v[48:51], a[104:107], a[8:11], v[48:51]
    s_mov_b32 m0, s65
    ds_read_b128 a[132:135], v2 offset:24576
    v_mfma_f32_16x16x32_bf16 v[48:51], a[108:111], a[12:15], v[48:51]
    ds_read_b128 a[136:139], v1 offset:25600
    v_mfma_f32_16x16x32_bf16 v[48:51], a[112:115], a[16:19], v[48:51]
    buffer_load_dwordx4 v7, s[8:11], s25 offen offset:128 lds
    v_mfma_f32_16x16x32_bf16 v[48:51], a[116:119], a[20:23], v[48:51]
    s_mov_b32 m0, s66
    ds_read_b128 a[140:143], v2 offset:25600
    v_mfma_f32_16x16x32_bf16 v[48:51], a[120:123], a[24:27], v[48:51]
    ds_read_b128 a[144:147], v1 offset:26624
    v_mfma_f32_16x16x32_bf16 v[48:51], a[124:127], a[28:31], v[48:51]
    buffer_load_dwordx4 v7, s[8:11], s25 offen offset:256 lds
    v_mfma_f32_16x16x32_bf16 v[52:55], a[124:127], a[60:63], 0
    s_mov_b32 m0, s67
    ds_read_b128 a[148:151], v2 offset:26624
    v_mfma_f32_16x16x32_bf16 v[52:55], a[120:123], a[56:59], v[52:55]
    ds_read_b128 a[152:155], v1 offset:27648
    v_mfma_f32_16x16x32_bf16 v[52:55], a[116:119], a[52:55], v[52:55]
    buffer_load_dwordx4 v7, s[8:11], s25 offen offset:384 lds
    v_mfma_f32_16x16x32_bf16 v[52:55], a[112:115], a[48:51], v[52:55]
    s_mov_b32 m0, s92
    ds_read_b128 a[156:159], v2 offset:27648
    v_fma_f32 v48, v48, s29, v8
    v_mfma_f32_16x16x32_bf16 v[52:55], a[108:111], a[44:47], v[52:55]
    s_add_u32 s25, s25, 16384
    buffer_load_dwordx4 v7, s[12:15], s26 offen lds
    v_mfma_f32_16x16x32_bf16 v[52:55], a[104:107], a[40:43], v[52:55]
    s_mov_b32 m0, s93
    buffer_store_dwordx4 v[244:247], v23, s[16:19], s98 offen offset:384
    v_fma_f32 v49, v49, s29, v8
    v_fma_f32 v50, v50, s29, v8
    v_mfma_f32_16x16x32_bf16 v[52:55], a[100:103], a[36:39], v[52:55]
    s_and_b32 s25, s25, 0x3ffff
    v_fma_f32 v51, v51, s29, v8
    v_mfma_f32_16x16x32_bf16 v[52:55], a[96:99], a[32:35], v[52:55]
    v_exp_f32 v48, v48
    v_mfma_f32_16x16x32_bf16 v[56:59], a[96:99], a[64:67], 0
    v_exp_f32 v49, v49
    v_mfma_f32_16x16x32_bf16 v[56:59], a[100:103], a[68:71], v[56:59]
    v_exp_f32 v50, v50
    v_mfma_f32_16x16x32_bf16 v[56:59], a[104:107], a[72:75], v[56:59]
    v_exp_f32 v51, v51
    v_mfma_f32_16x16x32_bf16 v[56:59], a[108:111], a[76:79], v[56:59]
    v_add_f32 v14, v14, v48
    v_cvt_pk_bf16_f32 v84, v48, v49
    v_mfma_f32_16x16x32_bf16 v[56:59], a[112:115], a[80:83], v[56:59]
    buffer_load_dwordx4 v7, s[12:15], s26 offen offset:128 lds
    v_mfma_f32_16x16x32_bf16 v[56:59], a[116:119], a[84:87], v[56:59]
    s_mov_b32 m0, s94
    v_add_f32 v14, v14, v49
    v_add_f32 v14, v14, v50
    v_mfma_f32_16x16x32_bf16 v[56:59], a[120:123], a[88:91], v[56:59]
    buffer_store_dwordx4 v[232:235], v23, s[16:19], s99 offen offset:384
    v_cvt_pk_bf16_f32 v85, v50, v51
    v_add_f32 v14, v14, v51
    v_mfma_f32_16x16x32_bf16 v[56:59], a[124:127], a[92:95], v[56:59]
    s_waitcnt lgkmcnt(0)
    v_fma_f32 v52, v52, s29, v9
    v_fma_f32 v53, v53, s29, v9
    v_mfma_f32_16x16x32_bf16 v[60:63], a[128:131], a[0:3], 0
    v_fma_f32 v54, v54, s29, v9
    v_fma_f32 v55, v55, s29, v9
    v_mfma_f32_16x16x32_bf16 v[60:63], a[132:135], a[4:7], v[60:63]
    v_exp_f32 v52, v52
    v_mfma_f32_16x16x32_bf16 v[60:63], a[136:139], a[8:11], v[60:63]
    v_exp_f32 v53, v53
    v_mfma_f32_16x16x32_bf16 v[60:63], a[140:143], a[12:15], v[60:63]
    v_exp_f32 v54, v54
    v_mfma_f32_16x16x32_bf16 v[60:63], a[144:147], a[16:19], v[60:63]
    v_exp_f32 v55, v55
    v_mfma_f32_16x16x32_bf16 v[60:63], a[148:151], a[20:23], v[60:63]
    ds_read_b64_tr_b16 a[160:161], v3 offset:0
    ds_read_b64_tr_b16 a[162:163], v3 offset:8192
    v_mfma_f32_16x16x32_bf16 v[60:63], a[152:155], a[24:27], v[60:63]
    v_add_f32 v15, v15, v52
    v_cvt_pk_bf16_f32 v88, v52, v53
    v_mfma_f32_16x16x32_bf16 v[60:63], a[156:159], a[28:31], v[60:63]
    v_add_f32 v15, v15, v53
    v_add_f32 v15, v15, v54
    v_mfma_f32_16x16x32_bf16 v[64:67], a[156:159], a[60:63], 0
    ds_read_b64_tr_b16 a[164:165], v4 offset:0
    ds_read_b64_tr_b16 a[166:167], v4 offset:8192
    v_mfma_f32_16x16x32_bf16 v[64:67], a[152:155], a[56:59], v[64:67]
    v_cvt_pk_bf16_f32 v89, v54, v55
    v_add_f32 v15, v15, v55
    v_mfma_f32_16x16x32_bf16 v[64:67], a[148:151], a[52:55], v[64:67]
    v_fma_f32 v56, v56, s29, v10
    v_fma_f32 v57, v57, s29, v10
    v_mfma_f32_16x16x32_bf16 v[64:67], a[144:147], a[48:51], v[64:67]
    ds_read_b64_tr_b16 a[168:169], v5 offset:0
    ds_read_b64_tr_b16 a[170:171], v5 offset:8192
    v_mfma_f32_16x16x32_bf16 v[64:67], a[140:143], a[44:47], v[64:67]
    v_fma_f32 v58, v58, s29, v10
    v_fma_f32 v59, v59, s29, v10
    v_mfma_f32_16x16x32_bf16 v[64:67], a[136:139], a[40:43], v[64:67]
    v_exp_f32 v56, v56
    v_mfma_f32_16x16x32_bf16 v[64:67], a[132:135], a[36:39], v[64:67]
    ds_read_b64_tr_b16 a[172:173], v6 offset:0
    ds_read_b64_tr_b16 a[174:175], v6 offset:8192
    v_mfma_f32_16x16x32_bf16 v[64:67], a[128:131], a[32:35], v[64:67]
    v_exp_f32 v57, v57
    v_mfma_f32_16x16x32_bf16 v[68:71], a[128:131], a[64:67], 0
    buffer_load_dwordx4 v7, s[12:15], s26 offen offset:256 lds
    v_mfma_f32_16x16x32_bf16 v[68:71], a[132:135], a[68:71], v[68:71]
    s_mov_b32 m0, s95
    ds_read_b64_tr_b16 a[176:177], v3 offset:1024
    ds_read_b64_tr_b16 a[178:179], v3 offset:9216
    v_mfma_f32_16x16x32_bf16 v[68:71], a[136:139], a[72:75], v[68:71]
    buffer_store_dwordx4 v[248:251], v23, s[16:19], s100 offen offset:384
    v_exp_f32 v58, v58
    v_mfma_f32_16x16x32_bf16 v[68:71], a[140:143], a[76:79], v[68:71]
    v_exp_f32 v59, v59
    v_mfma_f32_16x16x32_bf16 v[68:71], a[144:147], a[80:83], v[68:71]
    ds_read_b64_tr_b16 a[180:181], v4 offset:1024
    ds_read_b64_tr_b16 a[182:183], v4 offset:9216
    v_mfma_f32_16x16x32_bf16 v[68:71], a[148:151], a[84:87], v[68:71]
    v_add_f32 v16, v16, v56
    v_cvt_pk_bf16_f32 v92, v56, v57
    v_mfma_f32_16x16x32_bf16 v[68:71], a[152:155], a[88:91], v[68:71]
    v_add_f32 v16, v16, v57
    v_add_f32 v16, v16, v58
    v_mfma_f32_16x16x32_bf16 v[68:71], a[156:159], a[92:95], v[68:71]
    s_waitcnt lgkmcnt(4)
    ds_read_b64_tr_b16 a[184:185], v5 offset:1024
    ds_read_b64_tr_b16 a[186:187], v5 offset:9216
    v_mfma_f32_16x16x32_bf16 v[96:99], a[160:163], v[72:75], 0
    v_cvt_pk_bf16_f32 v93, v58, v59
    v_add_f32 v16, v16, v59
    v_mfma_f32_16x16x32_bf16 v[100:103], a[160:163], v[76:79], 0
    v_fma_f32 v60, v60, s29, v8
    v_fma_f32 v61, v61, s29, v8
    v_mfma_f32_16x16x32_bf16 v[104:107], a[160:163], v[80:83], 0
    ds_read_b64_tr_b16 a[188:189], v6 offset:1024
    ds_read_b64_tr_b16 a[190:191], v6 offset:9216
    v_mfma_f32_16x16x32_bf16 v[116:119], a[164:167], v[80:83], 0
    v_fma_f32 v62, v62, s29, v8
    v_fma_f32 v63, v63, s29, v8
    v_mfma_f32_16x16x32_bf16 v[112:115], a[164:167], v[76:79], 0
    v_exp_f32 v60, v60
    v_mfma_f32_16x16x32_bf16 v[108:111], a[164:167], v[72:75], 0
    ds_read_b64_tr_b16 a[160:161], v3 offset:2048
    ds_read_b64_tr_b16 a[162:163], v3 offset:10240
    v_mfma_f32_16x16x32_bf16 v[120:123], a[168:171], v[72:75], 0
    v_exp_f32 v61, v61
    v_mfma_f32_16x16x32_bf16 v[124:127], a[168:171], v[76:79], 0
    v_exp_f32 v62, v62
    v_mfma_f32_16x16x32_bf16 v[128:131], a[168:171], v[80:83], 0
    ds_read_b64_tr_b16 a[164:165], v4 offset:2048
    ds_read_b64_tr_b16 a[166:167], v4 offset:10240
    v_mfma_f32_16x16x32_bf16 v[140:143], a[172:175], v[80:83], 0
    v_exp_f32 v63, v63
    v_mfma_f32_16x16x32_bf16 v[136:139], a[172:175], v[76:79], 0
    buffer_store_dwordx4 v[236:239], v23, s[16:19], s101 offen offset:384
    v_add_f32 v14, v14, v60
    v_cvt_pk_bf16_f32 v86, v60, v61
    v_mfma_f32_16x16x32_bf16 v[132:135], a[172:175], v[72:75], 0
    s_waitcnt lgkmcnt(4)
    ds_read_b64_tr_b16 a[168:169], v5 offset:2048
    ds_read_b64_tr_b16 a[170:171], v5 offset:10240
    v_mfma_f32_16x16x32_bf16 v[144:147], a[176:179], v[72:75], 0
    buffer_load_dwordx4 v7, s[12:15], s26 offen offset:384 lds
    v_mfma_f32_16x16x32_bf16 v[148:151], a[176:179], v[76:79], 0
    s_add_u32 s26, s26, 16384
    v_add_f32 v14, v14, v61
    v_add_f32 v14, v14, v62
    v_mfma_f32_16x16x32_bf16 v[152:155], a[176:179], v[80:83], 0
    s_and_b32 s26, s26, 0x3ffff
    ds_read_b64_tr_b16 a[172:173], v6 offset:2048
    ds_read_b64_tr_b16 a[174:175], v6 offset:10240
    v_mfma_f32_16x16x32_bf16 v[164:167], a[180:183], v[80:83], 0
    v_cvt_pk_bf16_f32 v87, v62, v63
    v_add_f32 v14, v14, v63
    v_mfma_f32_16x16x32_bf16 v[160:163], a[180:183], v[76:79], 0
    v_fma_f32 v64, v64, s29, v9
    v_fma_f32 v65, v65, s29, v9
    v_mfma_f32_16x16x32_bf16 v[156:159], a[180:183], v[72:75], 0
    ds_read_b64_tr_b16 a[176:177], v3 offset:3072
    v_fma_f32 v66, v66, s29, v9
    v_mfma_f32_16x16x32_bf16 v[168:171], a[184:187], v[72:75], 0
    ds_read_b64_tr_b16 a[178:179], v3 offset:11264
    v_fma_f32 v67, v67, s29, v9
    v_mfma_f32_16x16x32_bf16 v[172:175], a[184:187], v[76:79], 0
    v_exp_f32 v64, v64
    v_mfma_f32_16x16x32_bf16 v[176:179], a[184:187], v[80:83], 0
    ds_read_b64_tr_b16 a[180:181], v4 offset:3072
    ds_read_b64_tr_b16 a[182:183], v4 offset:11264
    v_mfma_f32_16x16x32_bf16 v[188:191], a[188:191], v[80:83], 0
    ds_read_b64_tr_b16 a[184:185], v5 offset:3072
    ds_read_b64_tr_b16 a[186:187], v5 offset:11264
    v_mfma_f32_16x16x32_bf16 v[184:187], a[188:191], v[76:79], 0
    v_exp_f32 v65, v65
    v_mfma_f32_16x16x32_bf16 v[180:183], a[188:191], v[72:75], 0
    s_waitcnt lgkmcnt(6)
    ds_read_b64_tr_b16 a[188:189], v6 offset:3072
    ds_read_b64_tr_b16 a[190:191], v6 offset:11264
    v_mfma_f32_16x16x32_bf16 v[192:195], a[160:163], v[72:75], 0
    v_exp_f32 v66, v66
    v_mfma_f32_16x16x32_bf16 v[196:199], a[160:163], v[76:79], 0
    v_exp_f32 v67, v67
    v_mfma_f32_16x16x32_bf16 v[200:203], a[160:163], v[80:83], 0
    v_add_f32 v15, v15, v64
    v_cvt_pk_bf16_f32 v90, v64, v65
    v_mfma_f32_16x16x32_bf16 v[212:215], a[164:167], v[80:83], 0
    v_add_f32 v15, v15, v65
    v_add_f32 v15, v15, v66
    v_mfma_f32_16x16x32_bf16 v[208:211], a[164:167], v[76:79], 0
    v_cvt_pk_bf16_f32 v91, v66, v67
    v_add_f32 v15, v15, v67
    v_mfma_f32_16x16x32_bf16 v[204:207], a[164:167], v[72:75], 0
    v_fma_f32 v68, v68, s29, v10
    v_fma_f32 v69, v69, s29, v10
    v_mfma_f32_16x16x32_bf16 v[216:219], a[168:171], v[72:75], 0
    v_fma_f32 v70, v70, s29, v10
    v_fma_f32 v71, v71, s29, v10
    v_mfma_f32_16x16x32_bf16 v[220:223], a[168:171], v[76:79], 0
    s_waitcnt vmcnt(18) lgkmcnt(0)
    v_exp_f32 v68, v68
    v_mfma_f32_16x16x32_bf16 v[224:227], a[168:171], v[80:83], 0
    s_barrier
    v_exp_f32 v69, v69
    v_mfma_f32_16x16x32_bf16 v[236:239], a[172:175], v[80:83], 0
    ds_read_b128 a[96:99], v1 offset:32768
    v_add_f32 v16, v16, v68
    v_mfma_f32_16x16x32_bf16 v[232:235], a[172:175], v[76:79], 0
    ds_read_b128 a[100:103], v2 offset:32768
    v_cvt_pk_bf16_f32 v94, v68, v69
    v_mfma_f32_16x16x32_bf16 v[228:231], a[172:175], v[72:75], 0
    ds_read_b128 a[104:107], v1 offset:33792
    v_add_f32 v16, v16, v69
    v_mfma_f32_16x16x32_bf16 v[240:243], a[176:179], v[72:75], 0
    ds_read_b128 a[108:111], v2 offset:33792
    v_mfma_f32_16x16x32_bf16 v[244:247], a[176:179], v[76:79], 0
    ds_read_b128 a[112:115], v1 offset:34816
    v_mfma_f32_16x16x32_bf16 v[248:251], a[176:179], v[80:83], 0
    ds_read_b128 a[116:119], v2 offset:34816
    v_mfma_f32_16x16x32_bf16 a[196:199], a[180:183], v[80:83], 0
    ds_read_b128 a[120:123], v1 offset:35840
    v_mfma_f32_16x16x32_bf16 a[192:195], a[180:183], v[76:79], 0
    ds_read_b128 a[124:127], v2 offset:35840
    v_mfma_f32_16x16x32_bf16 v[252:255], a[180:183], v[72:75], 0
    v_exp_f32 v70, v70
    v_mfma_f32_16x16x32_bf16 a[200:203], a[184:187], v[72:75], 0
    v_exp_f32 v71, v71
    v_mfma_f32_16x16x32_bf16 a[204:207], a[184:187], v[76:79], 0
    v_add_f32 v16, v16, v70
    v_cvt_pk_bf16_f32 v95, v70, v71
    v_mfma_f32_16x16x32_bf16 a[208:211], a[184:187], v[80:83], 0
    v_add_f32 v16, v16, v71
    v_mfma_f32_16x16x32_bf16 a[220:223], a[188:191], v[80:83], 0
    v_mfma_f32_16x16x32_bf16 a[216:219], a[188:191], v[76:79], 0
    v_mfma_f32_16x16x32_bf16 a[212:215], a[188:191], v[72:75], 0
    s_waitcnt lgkmcnt(0)
    s_branch L_u1
L_tail1:
    v_mfma_f32_16x16x32_bf16 v[48:51], a[96:99], a[0:3], 0
    s_add_u32 s96, s31, 0
    ds_read_b128 a[128:131], v1 offset:57344
    ds_read_b128 a[132:135], v2 offset:57344
    v_mfma_f32_16x16x32_bf16 v[48:51], a[100:103], a[4:7], v[48:51]
    s_add_u32 s97, s31, 4096
    ds_read_b128 a[136:139], v1 offset:58368
    ds_read_b128 a[140:143], v2 offset:58368
    v_mfma_f32_16x16x32_bf16 v[48:51], a[104:107], a[8:11], v[48:51]
    s_add_u32 s98, s31, 8192
    ds_read_b128 a[144:147], v1 offset:59392
    ds_read_b128 a[148:151], v2 offset:59392
    v_mfma_f32_16x16x32_bf16 v[48:51], a[108:111], a[12:15], v[48:51]
    s_add_u32 s99, s31, 12288
    ds_read_b128 a[152:155], v1 offset:60416
    v_and_b32 v34, 15, v0
    v_mfma_f32_16x16x32_bf16 v[48:51], a[112:115], a[16:19], v[48:51]
    s_add_u32 s100, s31, 16384
    ds_read_b128 a[156:159], v2 offset:60416
    v_lshlrev_b32 v34, 7, v34
    v_mfma_f32_16x16x32_bf16 v[48:51], a[116:119], a[20:23], v[48:51]
    s_add_u32 s101, s31, 20480
    s_lshr_b32 s45, s2, 3
    s_add_u32 s45, s45, 1
    v_mfma_f32_16x16x32_bf16 v[48:51], a[120:123], a[24:27], v[48:51]
    s_lshl_b32 s45, s45, 14
    s_add_u32 s45, s45, s26
    s_and_b32 s45, s45, 0x3c000
    s_and_b32 s46, s2, 7
    s_lshl_b32 s46, s46, 11
    s_add_u32 s45, s45, s46
    v_mfma_f32_16x16x32_bf16 v[48:51], a[124:127], a[28:31], v[48:51]
    s_mov_b32 m0, s72
    buffer_load_dword v45, v34, s[12:15], s45 offen
    v_mfma_f32_16x16x32_bf16 v[52:55], a[124:127], a[60:63], 0
    v_mov_b32 v39, 0x3f803f80
    v_accvgpr_write_b32 a160, v39
    v_mfma_f32_16x16x32_bf16 v[52:55], a[120:123], a[56:59], v[52:55]
    v_accvgpr_write_b32 a161, v39
    v_accvgpr_write_b32 a162, v39
    v_accvgpr_write_b32 a163, v39
    v_mfma_f32_16x16x32_bf16 v[52:55], a[116:119], a[52:55], v[52:55]
    v_mov_b32 v36, v14
    v_mov_b32 v37, v15
    v_mov_b32 v38, v16
    v_permlane32_swap_b32 v14, v36
    v_permlane32_swap_b32 v15, v37
    v_mfma_f32_16x16x32_bf16 v[52:55], a[112:115], a[48:51], v[52:55]
    buffer_load_dwordx4 v7, s[8:11], s25 offen lds
    v_permlane32_swap_b32 v16, v38
    v_add_f32 v14, v14, v36
    v_add_u32 v40, 0xffff0000, v3
    v_add_u32 v41, 0xffff0000, v4
    v_add_u32 v42, 0xffff0000, v5
    v_add_u32 v43, 0xffff0000, v6
    v_add_f32 v15, v15, v37
    v_add_f32 v16, v16, v38
    v_mov_b32 v36, v14
    v_mov_b32 v37, v15
    v_mfma_f32_16x16x32_bf16 v[52:55], a[108:111], a[44:47], v[52:55]
    s_mov_b32 m0, s73
    v_mov_b32 v38, v16
    v_permlane16_swap_b32 v14, v36
    v_permlane16_swap_b32 v15, v37
    v_permlane16_swap_b32 v16, v38
    v_add_f32 v14, v14, v36
    v_add_f32 v15, v15, v37
    v_mfma_f32_16x16x32_bf16 v[52:55], a[104:107], a[40:43], v[52:55]
    s_waitcnt lgkmcnt(0)
    buffer_load_dwordx4 v7, s[8:11], s25 offen offset:128 lds
    v_add_f32 v16, v16, v38
    v_mfma_f32_16x16x32_bf16 v[52:55], a[100:103], a[36:39], v[52:55]
    s_mov_b32 m0, s74
    v_fma_f32 v48, v48, s29, v8
    s_waitcnt vmcnt(20)
    v_mfma_f32_16x16x32_bf16 v[52:55], a[96:99], a[32:35], v[52:55]
    s_barrier
    v_fma_f32 v49, v49, s29, v8
    v_fma_f32 v50, v50, s29, v8
    v_mfma_f32_16x16x32_bf16 v[56:59], a[96:99], a[64:67], 0
    v_fma_f32 v51, v51, s29, v8
    v_accvgpr_write_b32 a224, v72
    v_mfma_f32_16x16x32_bf16 v[56:59], a[100:103], a[68:71], v[56:59]
    buffer_load_dwordx4 v7, s[8:11], s25 offen offset:256 lds
    v_mfma_f32_16x16x32_bf16 v[56:59], a[104:107], a[72:75], v[56:59]
    s_mov_b32 m0, s75
    v_exp_f32 v48, v48
    v_mfma_f32_16x16x32_bf16 v[56:59], a[108:111], a[76:79], v[56:59]
    v_exp_f32 v49, v49
    v_mfma_f32_16x16x32_bf16 v[56:59], a[112:115], a[80:83], v[56:59]
    v_exp_f32 v50, v50
    v_mfma_f32_16x16x32_bf16 v[56:59], a[116:119], a[84:87], v[56:59]
    buffer_load_dwordx4 v7, s[8:11], s25 offen offset:384 lds
    v_mfma_f32_16x16x32_bf16 v[56:59], a[120:123], a[88:91], v[56:59]
    s_mov_b32 m0, s84
    s_add_u32 s25, s25, 16384
    v_cvt_pk_bf16_f32 v84, v48, v49
    v_mfma_f32_16x16x32_bf16 v[56:59], a[124:127], a[92:95], v[56:59]
    s_and_b32 s25, s25, 0x3ffff
    v_exp_f32 v51, v51
    v_mfma_f32_16x16x32_bf16 v[60:63], a[128:131], a[0:3], 0
    v_cvt_pk_bf16_f32 v85, v50, v51
    v_fma_f32 v52, v52, s29, v9
    v_mfma_f32_16x16x32_bf16 v[60:63], a[132:135], a[4:7], v[60:63]
    buffer_load_dwordx4 v7, s[12:15], s26 offen lds
    s_mov_b32 m0, s85
    v_mfma_f32_16x16x32_bf16 v[60:63], a[136:139], a[8:11], v[60:63]
    ds_read_b128 a[96:99], v1 offset:0
    ds_read_b128 a[100:103], v2 offset:0
    v_mfma_f32_16x16x32_bf16 v[60:63], a[140:143], a[12:15], v[60:63]
    ds_read_b128 a[104:107], v1 offset:1024
    ds_read_b128 a[108:111], v2 offset:1024
    v_mfma_f32_16x16x32_bf16 v[60:63], a[144:147], a[16:19], v[60:63]
    ds_read_b128 a[112:115], v1 offset:2048
    v_fma_f32 v53, v53, s29, v9
    v_mfma_f32_16x16x32_bf16 v[60:63], a[148:151], a[20:23], v[60:63]
    buffer_load_dwordx4 v7, s[12:15], s26 offen offset:128 lds
    s_mov_b32 m0, s86
    v_fma_f32 v54, v54, s29, v9
    v_mfma_f32_16x16x32_bf16 v[60:63], a[152:155], a[24:27], v[60:63]
    v_fma_f32 v55, v55, s29, v9
    v_exp_f32 v52, v52
    v_exp_f32 v53, v53
    v_mfma_f32_16x16x32_bf16 v[60:63], a[156:159], a[28:31], v[60:63]
    ds_read_b128 a[116:119], v2 offset:2048
    ds_read_b128 a[120:123], v1 offset:3072
    v_exp_f32 v54, v54
    v_mfma_f32_16x16x32_bf16 v[64:67], a[156:159], a[60:63], 0
    buffer_load_dwordx4 v7, s[12:15], s26 offen offset:256 lds
    s_mov_b32 m0, s87
    v_exp_f32 v55, v55
    v_cvt_pk_bf16_f32 v88, v52, v53
    v_cvt_pk_bf16_f32 v89, v54, v55
    v_mfma_f32_16x16x32_bf16 v[64:67], a[152:155], a[56:59], v[64:67]
    ds_read_b128 a[124:127], v2 offset:3072
    v_accvgpr_write_b32 a225, v73
    v_accvgpr_write_b32 a226, v74
    v_mfma_f32_16x16x32_bf16 v[64:67], a[148:151], a[52:55], v[64:67]
    v_accvgpr_write_b32 a227, v75
    v_accvgpr_write_b32 a228, v76
    v_mfma_f32_16x16x32_bf16 v[64:67], a[144:147], a[48:51], v[64:67]
    buffer_load_dwordx4 v7, s[12:15], s26 offen offset:384 lds
    s_mov_b32 m0, s76
    v_accvgpr_write_b32 a229, v77
    v_accvgpr_write_b32 a230, v78
    v_mfma_f32_16x16x32_bf16 v[64:67], a[140:143], a[44:47], v[64:67]
    s_add_u32 s26, s26, 16384
    v_accvgpr_write_b32 a231, v79
    v_fma_f32 v56, v56, s29, v10
    v_mfma_f32_16x16x32_bf16 v[64:67], a[136:139], a[40:43], v[64:67]
    s_and_b32 s26, s26, 0x3ffff
    v_accvgpr_write_b32 a232, v80
    v_fma_f32 v57, v57, s29, v10
    v_accvgpr_write_b32 a233, v81
    v_fma_f32 v58, v58, s29, v10
    v_mfma_f32_16x16x32_bf16 v[64:67], a[132:135], a[36:39], v[64:67]
    buffer_load_dwordx4 v7, s[8:11], s25 offen lds
    s_mov_b32 m0, s77
    v_fma_f32 v59, v59, s29, v10
    v_accvgpr_write_b32 a234, v82
    v_exp_f32 v56, v56
    v_accvgpr_write_b32 a235, v83
    v_exp_f32 v57, v57
    v_mfma_f32_16x16x32_bf16 v[64:67], a[128:131], a[32:35], v[64:67]
    v_exp_f32 v58, v58
    v_exp_f32 v59, v59
    v_mfma_f32_16x16x32_bf16 v[68:71], a[128:131], a[64:67], 0
    buffer_load_dwordx4 v7, s[8:11], s25 offen offset:128 lds
    s_mov_b32 m0, s78
    v_cvt_pk_bf16_f32 v92, v56, v57
    v_cvt_pk_bf16_f32 v93, v58, v59
    v_mfma_f32_16x16x32_bf16 v[68:71], a[132:135], a[68:71], v[68:71]
    v_fma_f32 v60, v60, s29, v8
    v_fma_f32 v61, v61, s29, v8
    v_mfma_f32_16x16x32_bf16 v[68:71], a[136:139], a[72:75], v[68:71]
    v_fma_f32 v62, v62, s29, v8
    v_fma_f32 v63, v63, s29, v8
    v_mfma_f32_16x16x32_bf16 v[68:71], a[140:143], a[76:79], v[68:71]
    v_exp_f32 v60, v60
    v_mfma_f32_16x16x32_bf16 v[68:71], a[144:147], a[80:83], v[68:71]
    buffer_load_dwordx4 v7, s[8:11], s25 offen offset:256 lds
    s_mov_b32 m0, s79
    v_mfma_f32_16x16x32_bf16 v[68:71], a[148:151], a[84:87], v[68:71]
    v_exp_f32 v61, v61
    v_mfma_f32_16x16x32_bf16 v[68:71], a[152:155], a[88:91], v[68:71]
    v_exp_f32 v62, v62
    v_mfma_f32_16x16x32_bf16 v[68:71], a[156:159], a[92:95], v[68:71]
    s_waitcnt lgkmcnt(0)
    v_exp_f32 v63, v63
    v_mfma_f32_16x16x32_bf16 v[48:51], a[96:99], a[0:3], 0
    buffer_load_dwordx4 v7, s[8:11], s25 offen offset:384 lds
    s_add_u32 s25, s25, 16384
    s_and_b32 s25, s25, 0x3ffff
    v_cvt_pk_bf16_f32 v86, v60, v61
    v_cvt_pk_bf16_f32 v87, v62, v63
    v_mfma_f32_16x16x32_bf16 v[48:51], a[100:103], a[4:7], v[48:51]
    s_mov_b32 m0, s64
    ds_read_b128 a[128:131], v1 offset:8192
    ds_read_b128 a[132:135], v2 offset:8192
    v_mfma_f32_16x16x32_bf16 a[164:167], a[160:163], v[84:87], 0
    ds_read_b128 a[136:139], v1 offset:9216
    ds_read_b128 a[140:143], v2 offset:9216
    v_mfma_f32_16x16x32_bf16 v[48:51], a[104:107], a[8:11], v[48:51]
    v_fma_f32 v64, v64, s29, v9
    v_fma_f32 v65, v65, s29, v9
    v_mfma_f32_16x16x32_bf16 v[48:51], a[108:111], a[12:15], v[48:51]
    ds_read_b128 a[144:147], v1 offset:10240
    ds_read_b128 a[148:151], v2 offset:10240
    v_mfma_f32_16x16x32_bf16 v[48:51], a[112:115], a[16:19], v[48:51]
    ds_read_b128 a[152:155], v1 offset:11264
    ds_read_b128 a[156:159], v2 offset:11264
    v_mfma_f32_16x16x32_bf16 v[48:51], a[116:119], a[20:23], v[48:51]
    v_fma_f32 v66, v66, s29, v9
    v_fma_f32 v67, v67, s29, v9
    v_mfma_f32_16x16x32_bf16 v[48:51], a[120:123], a[24:27], v[48:51]
    v_exp_f32 v64, v64
    v_exp_f32 v65, v65
    v_mfma_f32_16x16x32_bf16 v[48:51], a[124:127], a[28:31], v[48:51]
    v_exp_f32 v66, v66
    v_exp_f32 v67, v67
    v_mfma_f32_16x16x32_bf16 v[52:55], a[124:127], a[60:63], 0
    v_cvt_pk_bf16_f32 v90, v64, v65
    v_cvt_pk_bf16_f32 v91, v66, v67
    v_mfma_f32_16x16x32_bf16 v[52:55], a[120:123], a[56:59], v[52:55]
    v_fma_f32 v68, v68, s29, v10
    v_fma_f32 v69, v69, s29, v10
    v_mfma_f32_16x16x32_bf16 a[168:171], a[160:163], v[88:91], 0
    v_fma_f32 v70, v70, s29, v10
    v_fma_f32 v71, v71, s29, v10
    v_mfma_f32_16x16x32_bf16 v[52:55], a[116:119], a[52:55], v[52:55]
    v_exp_f32 v68, v68
    v_mfma_f32_16x16x32_bf16 v[52:55], a[112:115], a[48:51], v[52:55]
    v_exp_f32 v69, v69
    v_mfma_f32_16x16x32_bf16 v[52:55], a[108:111], a[44:47], v[52:55]
    s_waitcnt lgkmcnt(0)
    v_exp_f32 v70, v70
    v_mfma_f32_16x16x32_bf16 v[52:55], a[104:107], a[40:43], v[52:55]
    s_waitcnt vmcnt(20)
    v_exp_f32 v71, v71
    v_mfma_f32_16x16x32_bf16 v[52:55], a[100:103], a[36:39], v[52:55]
    s_barrier
    buffer_load_dwordx4 v7, s[12:15], s26 offen lds
    v_mfma_f32_16x16x32_bf16 v[52:55], a[96:99], a[32:35], v[52:55]
    s_mov_b32 m0, s65
    v_cvt_pk_bf16_f32 v94, v68, v69
    v_cvt_pk_bf16_f32 v95, v70, v71
    v_mfma_f32_16x16x32_bf16 v[56:59], a[96:99], a[64:67], 0
    v_fma_f32 v48, v48, s29, v8
    v_fma_f32 v49, v49, s29, v8
    v_mfma_f32_16x16x32_bf16 a[172:175], a[160:163], v[92:95], 0
    v_fma_f32 v50, v50, s29, v8
    v_fma_f32 v51, v51, s29, v8
    v_mfma_f32_16x16x32_bf16 v[56:59], a[100:103], a[68:71], v[56:59]
    buffer_load_dwordx4 v7, s[12:15], s26 offen offset:128 lds
    v_mfma_f32_16x16x32_bf16 v[56:59], a[104:107], a[72:75], v[56:59]
    s_mov_b32 m0, s66
    v_exp_f32 v48, v48
    v_mfma_f32_16x16x32_bf16 v[56:59], a[108:111], a[76:79], v[56:59]
    v_exp_f32 v49, v49
    v_mfma_f32_16x16x32_bf16 v[56:59], a[112:115], a[80:83], v[56:59]
    v_exp_f32 v50, v50
    v_mfma_f32_16x16x32_bf16 v[56:59], a[116:119], a[84:87], v[56:59]
    buffer_load_dwordx4 v7, s[12:15], s26 offen offset:256 lds
    v_mfma_f32_16x16x32_bf16 v[56:59], a[120:123], a[88:91], v[56:59]
    s_mov_b32 m0, s67
    v_exp_f32 v51, v51
    v_mfma_f32_16x16x32_bf16 v[56:59], a[124:127], a[92:95], v[56:59]
    v_cvt_pk_bf16_f32 v72, v48, v49
    v_cvt_pk_bf16_f32 v73, v50, v51
    v_mfma_f32_16x16x32_bf16 v[60:63], a[128:131], a[0:3], 0
    ds_read_b128 a[96:99], v1 offset:16384
    ds_read_b128 a[100:103], v2 offset:16384
    v_mfma_f32_16x16x32_bf16 v[60:63], a[132:135], a[4:7], v[60:63]
    buffer_load_dwordx4 v7, s[12:15], s26 offen offset:384 lds
    v_mfma_f32_16x16x32_bf16 v[60:63], a[136:139], a[8:11], v[60:63]
    s_add_u32 s26, s26, 16384
    ds_read_b128 a[104:107], v1 offset:17408
    ds_read_b128 a[108:111], v2 offset:17408
    v_mfma_f32_16x16x32_bf16 v[60:63], a[140:143], a[12:15], v[60:63]
    s_and_b32 s26, s26, 0x3ffff
    v_fma_f32 v52, v52, s29, v9
    v_fma_f32 v53, v53, s29, v9
    v_mfma_f32_16x16x32_bf16 v[60:63], a[144:147], a[16:19], v[60:63]
    s_mov_b32 m0, s68
    ds_read_b128 a[112:115], v1 offset:18432
    v_fma_f32 v54, v54, s29, v9
    v_mfma_f32_16x16x32_bf16 v[60:63], a[148:151], a[20:23], v[60:63]
    v_fma_f32 v55, v55, s29, v9
    v_accvgpr_write_b32 a236, v84
    v_mfma_f32_16x16x32_bf16 v[60:63], a[152:155], a[24:27], v[60:63]
    ds_read_b128 a[116:119], v2 offset:18432
    v_exp_f32 v52, v52
    v_exp_f32 v53, v53
    v_mfma_f32_16x16x32_bf16 v[60:63], a[156:159], a[28:31], v[60:63]
    ds_read_b128 a[120:123], v1 offset:19456
    v_exp_f32 v54, v54
    v_exp_f32 v55, v55
    v_mfma_f32_16x16x32_bf16 v[64:67], a[156:159], a[60:63], 0
    ds_read_b128 a[124:127], v2 offset:19456
    v_cvt_pk_bf16_f32 v76, v52, v53
    v_cvt_pk_bf16_f32 v77, v54, v55
    v_mfma_f32_16x16x32_bf16 v[64:67], a[152:155], a[56:59], v[64:67]
    v_accvgpr_write_b32 a237, v85
    v_accvgpr_write_b32 a238, v86
    v_mfma_f32_16x16x32_bf16 v[64:67], a[148:151], a[52:55], v[64:67]
    v_accvgpr_write_b32 a239, v87
    v_accvgpr_write_b32 a240, v88
    v_mfma_f32_16x16x32_bf16 v[64:67], a[144:147], a[48:51], v[64:67]
    v_accvgpr_write_b32 a241, v89
    v_accvgpr_write_b32 a242, v90
    v_mfma_f32_16x16x32_bf16 v[64:67], a[140:143], a[44:47], v[64:67]
    v_accvgpr_write_b32 a243, v91
    v_fma_f32 v56, v56, s29, v10
    v_mfma_f32_16x16x32_bf16 v[64:67], a[136:139], a[40:43], v[64:67]
    v_accvgpr_write_b32 a244, v92
    v_fma_f32 v57, v57, s29, v10
    v_accvgpr_write_b32 a245, v93
    v_fma_f32 v58, v58, s29, v10
    v_mfma_f32_16x16x32_bf16 v[64:67], a[132:135], a[36:39], v[64:67]
    v_fma_f32 v59, v59, s29, v10
    v_accvgpr_write_b32 a246, v94
    v_exp_f32 v56, v56
    v_accvgpr_write_b32 a247, v95
    v_exp_f32 v57, v57
    v_mfma_f32_16x16x32_bf16 v[64:67], a[128:131], a[32:35], v[64:67]
    v_exp_f32 v58, v58
    v_exp_f32 v59, v59
    v_mfma_f32_16x16x32_bf16 v[68:71], a[128:131], a[64:67], 0
    v_cvt_pk_bf16_f32 v80, v56, v57
    v_cvt_pk_bf16_f32 v81, v58, v59
    v_mfma_f32_16x16x32_bf16 v[68:71], a[132:135], a[68:71], v[68:71]
    v_fma_f32 v60, v60, s29, v8
    v_fma_f32 v61, v61, s29, v8
    v_mfma_f32_16x16x32_bf16 v[68:71], a[136:139], a[72:75], v[68:71]
    v_fma_f32 v62, v62, s29, v8
    v_fma_f32 v63, v63, s29, v8
    v_mfma_f32_16x16x32_bf16 v[68:71], a[140:143], a[76:79], v[68:71]
    v_exp_f32 v60, v60
    v_mfma_f32_16x16x32_bf16 v[68:71], a[144:147], a[80:83], v[68:71]
    v_exp_f32 v61, v61
    v_mfma_f32_16x16x32_bf16 v[68:71], a[148:151], a[84:87], v[68:71]
    v_exp_f32 v62, v62
    v_mfma_f32_16x16x32_bf16 v[68:71], a[152:155], a[88:91], v[68:71]
    v_exp_f32 v63, v63
    v_mfma_f32_16x16x32_bf16 v[68:71], a[156:159], a[92:95], v[68:71]
    s_waitcnt lgkmcnt(0)
    v_cvt_pk_bf16_f32 v74, v60, v61
    v_cvt_pk_bf16_f32 v75, v62, v63
    v_mfma_f32_16x16x32_bf16 v[48:51], a[96:99], a[0:3], 0
    ds_read_b128 a[128:131], v1 offset:24576
    ds_read_b128 a[132:135], v2 offset:24576
    v_mfma_f32_16x16x32_bf16 a[164:167], a[160:163], v[72:75], a[164:167]
    ds_read_b128 a[136:139], v1 offset:25600
    ds_read_b128 a[140:143], v2 offset:25600
    v_mfma_f32_16x16x32_bf16 v[48:51], a[100:103], a[4:7], v[48:51]
    v_fma_f32 v64, v64, s29, v9
    v_fma_f32 v65, v65, s29, v9
    v_mfma_f32_16x16x32_bf16 v[48:51], a[104:107], a[8:11], v[48:51]
    ds_read_b128 a[144:147], v1 offset:26624
    ds_read_b128 a[148:151], v2 offset:26624
    v_mfma_f32_16x16x32_bf16 v[48:51], a[108:111], a[12:15], v[48:51]
    ds_read_b128 a[152:155], v1 offset:27648
    ds_read_b128 a[156:159], v2 offset:27648
    v_mfma_f32_16x16x32_bf16 v[48:51], a[112:115], a[16:19], v[48:51]
    v_fma_f32 v66, v66, s29, v9
    v_fma_f32 v67, v67, s29, v9
    v_mfma_f32_16x16x32_bf16 v[48:51], a[116:119], a[20:23], v[48:51]
    v_exp_f32 v64, v64
    v_mfma_f32_16x16x32_bf16 v[48:51], a[120:123], a[24:27], v[48:51]
    v_exp_f32 v65, v65
    v_mfma_f32_16x16x32_bf16 v[48:51], a[124:127], a[28:31], v[48:51]
    v_exp_f32 v66, v66
    v_exp_f32 v67, v67
    v_mfma_f32_16x16x32_bf16 v[52:55], a[124:127], a[60:63], 0
    v_cvt_pk_bf16_f32 v78, v64, v65
    v_cvt_pk_bf16_f32 v79, v66, v67
    v_mfma_f32_16x16x32_bf16 v[52:55], a[120:123], a[56:59], v[52:55]
    v_fma_f32 v68, v68, s29, v10
    v_fma_f32 v69, v69, s29, v10
    v_mfma_f32_16x16x32_bf16 a[168:171], a[160:163], v[76:79], a[168:171]
    v_fma_f32 v70, v70, s29, v10
    v_fma_f32 v71, v71, s29, v10
    v_mfma_f32_16x16x32_bf16 v[52:55], a[116:119], a[52:55], v[52:55]
    v_exp_f32 v68, v68
    v_mfma_f32_16x16x32_bf16 v[52:55], a[112:115], a[48:51], v[52:55]
    v_exp_f32 v69, v69
    v_mfma_f32_16x16x32_bf16 v[52:55], a[108:111], a[44:47], v[52:55]
    s_waitcnt lgkmcnt(0)
    v_exp_f32 v70, v70
    v_mfma_f32_16x16x32_bf16 v[52:55], a[104:107], a[40:43], v[52:55]
    s_waitcnt vmcnt(12)
    v_exp_f32 v71, v71
    v_mfma_f32_16x16x32_bf16 v[52:55], a[100:103], a[36:39], v[52:55]
    s_barrier
    buffer_load_dwordx4 v7, s[12:15], s26 offen lds
    v_mfma_f32_16x16x32_bf16 v[52:55], a[96:99], a[32:35], v[52:55]
    s_mov_b32 m0, s69
    v_cvt_pk_bf16_f32 v82, v68, v69
    v_cvt_pk_bf16_f32 v83, v70, v71
    v_mfma_f32_16x16x32_bf16 v[56:59], a[96:99], a[64:67], 0
    v_fma_f32 v48, v48, s29, v8
    v_fma_f32 v49, v49, s29, v8
    v_mfma_f32_16x16x32_bf16 a[172:175], a[160:163], v[80:83], a[172:175]
    v_fma_f32 v50, v50, s29, v8
    v_fma_f32 v51, v51, s29, v8
    v_mfma_f32_16x16x32_bf16 v[56:59], a[100:103], a[68:71], v[56:59]
    buffer_load_dwordx4 v7, s[12:15], s26 offen offset:128 lds
    v_mfma_f32_16x16x32_bf16 v[56:59], a[104:107], a[72:75], v[56:59]
    s_mov_b32 m0, s70
    v_exp_f32 v48, v48
    v_mfma_f32_16x16x32_bf16 v[56:59], a[108:111], a[76:79], v[56:59]
    v_exp_f32 v49, v49
    v_mfma_f32_16x16x32_bf16 v[56:59], a[112:115], a[80:83], v[56:59]
    v_exp_f32 v50, v50
    v_mfma_f32_16x16x32_bf16 v[56:59], a[116:119], a[84:87], v[56:59]
    buffer_load_dwordx4 v7, s[12:15], s26 offen offset:256 lds
    v_mfma_f32_16x16x32_bf16 v[56:59], a[120:123], a[88:91], v[56:59]
    s_mov_b32 m0, s71
    v_exp_f32 v51, v51
    v_mfma_f32_16x16x32_bf16 v[56:59], a[124:127], a[92:95], v[56:59]
    v_cvt_pk_bf16_f32 v84, v48, v49
    v_cvt_pk_bf16_f32 v85, v50, v51
    v_mfma_f32_16x16x32_bf16 v[60:63], a[128:131], a[0:3], 0
    ds_read_b128 a[96:99], v1 offset:32768
    ds_read_b128 a[100:103], v2 offset:32768
    v_mfma_f32_16x16x32_bf16 v[60:63], a[132:135], a[4:7], v[60:63]
    buffer_load_dwordx4 v7, s[12:15], s26 offen offset:384 lds
    v_mfma_f32_16x16x32_bf16 v[60:63], a[136:139], a[8:11], v[60:63]
    s_add_u32 s26, s26, 16384
    ds_read_b128 a[104:107], v1 offset:33792
    ds_read_b128 a[108:111], v2 offset:33792
    v_mfma_f32_16x16x32_bf16 v[60:63], a[140:143], a[12:15], v[60:63]
    s_and_b32 s26, s26, 0x3ffff
    v_fma_f32 v52, v52, s29, v9
    v_fma_f32 v53, v53, s29, v9
    v_mfma_f32_16x16x32_bf16 v[60:63], a[144:147], a[16:19], v[60:63]
    ds_read_b128 a[112:115], v1 offset:34816
    v_fma_f32 v54, v54, s29, v9
    v_mfma_f32_16x16x32_bf16 v[60:63], a[148:151], a[20:23], v[60:63]
    v_fma_f32 v55, v55, s29, v9
    v_accvgpr_write_b32 a248, v72
    v_mfma_f32_16x16x32_bf16 v[60:63], a[152:155], a[24:27], v[60:63]
    ds_read_b128 a[116:119], v2 offset:34816
    v_exp_f32 v52, v52
    v_exp_f32 v53, v53
    v_mfma_f32_16x16x32_bf16 v[60:63], a[156:159], a[28:31], v[60:63]
    ds_read_b128 a[120:123], v1 offset:35840
    v_exp_f32 v54, v54
    v_exp_f32 v55, v55
    v_mfma_f32_16x16x32_bf16 v[64:67], a[156:159], a[60:63], 0
    ds_read_b128 a[124:127], v2 offset:35840
    v_cvt_pk_bf16_f32 v88, v52, v53
    v_cvt_pk_bf16_f32 v89, v54, v55
    v_mfma_f32_16x16x32_bf16 v[64:67], a[152:155], a[56:59], v[64:67]
    v_accvgpr_write_b32 a249, v73
    v_accvgpr_write_b32 a250, v74
    v_mfma_f32_16x16x32_bf16 v[64:67], a[148:151], a[52:55], v[64:67]
    v_accvgpr_write_b32 a251, v75
    v_accvgpr_write_b32 a252, v76
    v_mfma_f32_16x16x32_bf16 v[64:67], a[144:147], a[48:51], v[64:67]
    v_accvgpr_write_b32 a253, v77
    v_accvgpr_write_b32 a254, v78
    v_mfma_f32_16x16x32_bf16 v[64:67], a[140:143], a[44:47], v[64:67]
    v_accvgpr_write_b32 a255, v79
    v_fma_f32 v56, v56, s29, v10
    v_mfma_f32_16x16x32_bf16 v[64:67], a[136:139], a[40:43], v[64:67]
    v_accvgpr_write_b32 a188, v80
    v_fma_f32 v57, v57, s29, v10
    v_accvgpr_write_b32 a189, v81
    v_fma_f32 v58, v58, s29, v10
    v_mfma_f32_16x16x32_bf16 v[64:67], a[132:135], a[36:39], v[64:67]
    v_fma_f32 v59, v59, s29, v10
    v_accvgpr_write_b32 a190, v82
    v_exp_f32 v56, v56
    v_accvgpr_write_b32 a191, v83
    v_exp_f32 v57, v57
    v_mfma_f32_16x16x32_bf16 v[64:67], a[128:131], a[32:35], v[64:67]
    v_exp_f32 v58, v58
    v_exp_f32 v59, v59
    v_mfma_f32_16x16x32_bf16 v[68:71], a[128:131], a[64:67], 0
    v_cvt_pk_bf16_f32 v92, v56, v57
    v_cvt_pk_bf16_f32 v93, v58, v59
    v_mfma_f32_16x16x32_bf16 v[68:71], a[132:135], a[68:71], v[68:71]
    v_fma_f32 v60, v60, s29, v8
    v_fma_f32 v61, v61, s29, v8
    v_mfma_f32_16x16x32_bf16 v[68:71], a[136:139], a[72:75], v[68:71]
    v_fma_f32 v62, v62, s29, v8
    v_fma_f32 v63, v63, s29, v8
    v_mfma_f32_16x16x32_bf16 v[68:71], a[140:143], a[76:79], v[68:71]
    v_exp_f32 v60, v60
    v_mfma_f32_16x16x32_bf16 v[68:71], a[144:147], a[80:83], v[68:71]
    v_exp_f32 v61, v61
    v_mfma_f32_16x16x32_bf16 v[68:71], a[148:151], a[84:87], v[68:71]
    v_exp_f32 v62, v62
    v_mfma_f32_16x16x32_bf16 v[68:71], a[152:155], a[88:91], v[68:71]
    v_exp_f32 v63, v63
    v_mfma_f32_16x16x32_bf16 v[68:71], a[156:159], a[92:95], v[68:71]
    s_waitcnt lgkmcnt(0)
    v_cvt_pk_bf16_f32 v86, v60, v61
    v_cvt_pk_bf16_f32 v87, v62, v63
    v_mfma_f32_16x16x32_bf16 v[48:51], a[96:99], a[0:3], 0
    ds_read_b128 a[128:131], v1 offset:40960
    ds_read_b128 a[132:135], v2 offset:40960
    v_mfma_f32_16x16x32_bf16 a[164:167], a[160:163], v[84:87], a[164:167]
    ds_read_b128 a[136:139], v1 offset:41984
    ds_read_b128 a[140:143], v2 offset:41984
    v_mfma_f32_16x16x32_bf16 v[48:51], a[100:103], a[4:7], v[48:51]
    v_fma_f32 v64, v64, s29, v9
    v_fma_f32 v65, v65, s29, v9
    v_mfma_f32_16x16x32_bf16 v[48:51], a[104:107], a[8:11], v[48:51]
    ds_read_b128 a[144:147], v1 offset:43008
    v_fma_f32 v66, v66, s29, v9
    v_mfma_f32_16x16x32_bf16 v[48:51], a[108:111], a[12:15], v[48:51]
    v_fma_f32 v67, v67, s29, v9
    v_fma_f32 v68, v68, s29, v10
    v_mfma_f32_16x16x32_bf16 v[48:51], a[112:115], a[16:19], v[48:51]
    ds_read_b128 a[148:151], v2 offset:43008
    v_fma_f32 v69, v69, s29, v10
    v_mfma_f32_16x16x32_bf16 v[48:51], a[116:119], a[20:23], v[48:51]
    v_exp_f32 v64, v64
    v_mfma_f32_16x16x32_bf16 v[48:51], a[120:123], a[24:27], v[48:51]
    v_exp_f32 v65, v65
    v_mfma_f32_16x16x32_bf16 v[48:51], a[124:127], a[28:31], v[48:51]
    ds_read_b128 a[152:155], v1 offset:44032
    v_exp_f32 v66, v66
    v_exp_f32 v67, v67
    v_mfma_f32_16x16x32_bf16 v[52:55], a[124:127], a[60:63], 0
    ds_read_b128 a[156:159], v2 offset:44032
    v_cvt_pk_bf16_f32 v90, v64, v65
    v_cvt_pk_bf16_f32 v91, v66, v67
    v_mfma_f32_16x16x32_bf16 v[52:55], a[120:123], a[56:59], v[52:55]
    v_fma_f32 v70, v70, s29, v10
    v_fma_f32 v71, v71, s29, v10
    v_mfma_f32_16x16x32_bf16 a[168:171], a[160:163], v[88:91], a[168:171]
    v_exp_f32 v68, v68
    v_mfma_f32_16x16x32_bf16 v[52:55], a[116:119], a[52:55], v[52:55]
    v_exp_f32 v69, v69
    v_mfma_f32_16x16x32_bf16 v[52:55], a[112:115], a[48:51], v[52:55]
    v_exp_f32 v70, v70
    v_mfma_f32_16x16x32_bf16 v[52:55], a[108:111], a[44:47], v[52:55]
    s_waitcnt vmcnt(8)
    v_exp_f32 v71, v71
    v_mfma_f32_16x16x32_bf16 v[52:55], a[104:107], a[40:43], v[52:55]
    s_barrier
    v_cvt_pk_bf16_f32 v94, v68, v69
    v_cvt_pk_bf16_f32 v95, v70, v71
    v_mfma_f32_16x16x32_bf16 v[52:55], a[100:103], a[36:39], v[52:55]
    v_fma_f32 v48, v48, s29, v8
    v_fma_f32 v49, v49, s29, v8
    v_mfma_f32_16x16x32_bf16 a[172:175], a[160:163], v[92:95], a[172:175]
    v_fma_f32 v50, v50, s29, v8
    v_fma_f32 v51, v51, s29, v8
    v_mfma_f32_16x16x32_bf16 v[52:55], a[96:99], a[32:35], v[52:55]
    v_exp_f32 v48, v48
    v_mfma_f32_16x16x32_bf16 v[56:59], a[96:99], a[64:67], 0
    v_exp_f32 v49, v49
    v_mfma_f32_16x16x32_bf16 v[56:59], a[100:103], a[68:71], v[56:59]
    v_exp_f32 v50, v50
    v_mfma_f32_16x16x32_bf16 v[56:59], a[104:107], a[72:75], v[56:59]
    v_exp_f32 v51, v51
    v_mfma_f32_16x16x32_bf16 v[56:59], a[108:111], a[76:79], v[56:59]
    v_cvt_pk_bf16_f32 v72, v48, v49
    v_cvt_pk_bf16_f32 v73, v50, v51
    v_mfma_f32_16x16x32_bf16 v[56:59], a[112:115], a[80:83], v[56:59]
    ds_read_b128 a[96:99], v1 offset:49152
    ds_read_b128 a[100:103], v2 offset:49152
    v_mfma_f32_16x16x32_bf16 v[56:59], a[116:119], a[84:87], v[56:59]
    ds_read_b128 a[104:107], v1 offset:50176
    ds_read_b128 a[108:111], v2 offset:50176
    v_mfma_f32_16x16x32_bf16 v[56:59], a[120:123], a[88:91], v[56:59]
    v_fma_f32 v52, v52, s29, v9
    v_fma_f32 v53, v53, s29, v9
    v_mfma_f32_16x16x32_bf16 v[56:59], a[124:127], a[92:95], v[56:59]
    s_waitcnt lgkmcnt(4)
    ds_read_b128 a[112:115], v1 offset:51200
    v_fma_f32 v54, v54, s29, v9
    v_mfma_f32_16x16x32_bf16 v[60:63], a[128:131], a[0:3], 0
    v_fma_f32 v55, v55, s29, v9
    v_accvgpr_write_b32 a184, v84
    v_mfma_f32_16x16x32_bf16 v[60:63], a[132:135], a[4:7], v[60:63]
    ds_read_b128 a[116:119], v2 offset:51200
    v_accvgpr_write_b32 a185, v85
    v_mfma_f32_16x16x32_bf16 v[60:63], a[136:139], a[8:11], v[60:63]
    v_exp_f32 v52, v52
    v_mfma_f32_16x16x32_bf16 v[60:63], a[140:143], a[12:15], v[60:63]
    v_exp_f32 v53, v53
    v_mfma_f32_16x16x32_bf16 v[60:63], a[144:147], a[16:19], v[60:63]
    ds_read_b128 a[120:123], v1 offset:52224
    v_cvt_pk_bf16_f32 v76, v52, v53
    v_mfma_f32_16x16x32_bf16 v[60:63], a[148:151], a[20:23], v[60:63]
    v_exp_f32 v54, v54
    v_mfma_f32_16x16x32_bf16 v[60:63], a[152:155], a[24:27], v[60:63]
    v_exp_f32 v55, v55
    v_mfma_f32_16x16x32_bf16 v[60:63], a[156:159], a[28:31], v[60:63]
    ds_read_b128 a[124:127], v2 offset:52224
    v_cvt_pk_bf16_f32 v77, v54, v55
    v_mfma_f32_16x16x32_bf16 v[64:67], a[156:159], a[60:63], 0
    v_accvgpr_write_b32 a186, v86
    v_accvgpr_write_b32 a187, v87
    v_mfma_f32_16x16x32_bf16 v[64:67], a[152:155], a[56:59], v[64:67]
    v_accvgpr_write_b32 a180, v88
    v_accvgpr_write_b32 a181, v89
    v_mfma_f32_16x16x32_bf16 v[64:67], a[148:151], a[52:55], v[64:67]
    v_accvgpr_write_b32 a182, v90
    v_accvgpr_write_b32 a183, v91
    v_mfma_f32_16x16x32_bf16 v[64:67], a[144:147], a[48:51], v[64:67]
    v_fma_f32 v56, v56, s29, v10
    v_accvgpr_write_b32 a176, v92
    v_mfma_f32_16x16x32_bf16 v[64:67], a[140:143], a[44:47], v[64:67]
    v_fma_f32 v57, v57, s29, v10
    v_accvgpr_write_b32 a177, v93
    v_mfma_f32_16x16x32_bf16 v[64:67], a[136:139], a[40:43], v[64:67]
    v_fma_f32 v58, v58, s29, v10
    v_fma_f32 v59, v59, s29, v10
    v_mfma_f32_16x16x32_bf16 v[64:67], a[132:135], a[36:39], v[64:67]
    v_accvgpr_write_b32 a178, v94
    v_exp_f32 v56, v56
    v_accvgpr_write_b32 a179, v95
    v_exp_f32 v57, v57
    v_mfma_f32_16x16x32_bf16 v[64:67], a[128:131], a[32:35], v[64:67]
    v_exp_f32 v58, v58
    v_exp_f32 v59, v59
    v_mfma_f32_16x16x32_bf16 v[68:71], a[128:131], a[64:67], 0
    v_cvt_pk_bf16_f32 v80, v56, v57
    v_cvt_pk_bf16_f32 v81, v58, v59
    v_mfma_f32_16x16x32_bf16 v[68:71], a[132:135], a[68:71], v[68:71]
    v_fma_f32 v60, v60, s29, v8
    v_fma_f32 v61, v61, s29, v8
    v_mfma_f32_16x16x32_bf16 v[68:71], a[136:139], a[72:75], v[68:71]
    v_fma_f32 v62, v62, s29, v8
    v_fma_f32 v63, v63, s29, v8
    v_mfma_f32_16x16x32_bf16 v[68:71], a[140:143], a[76:79], v[68:71]
    v_exp_f32 v60, v60
    v_mfma_f32_16x16x32_bf16 v[68:71], a[144:147], a[80:83], v[68:71]
    v_exp_f32 v61, v61
    v_mfma_f32_16x16x32_bf16 v[68:71], a[148:151], a[84:87], v[68:71]
    v_exp_f32 v62, v62
    v_mfma_f32_16x16x32_bf16 v[68:71], a[152:155], a[88:91], v[68:71]
    v_exp_f32 v63, v63
    v_mfma_f32_16x16x32_bf16 v[68:71], a[156:159], a[92:95], v[68:71]
    s_waitcnt lgkmcnt(0)
    v_cvt_pk_bf16_f32 v74, v60, v61
    v_cvt_pk_bf16_f32 v75, v62, v63
    v_mfma_f32_16x16x32_bf16 v[48:51], a[96:99], a[0:3], 0
    ds_read_b128 a[128:131], v1 offset:57344
    ds_read_b128 a[132:135], v2 offset:57344
    v_mfma_f32_16x16x32_bf16 a[164:167], a[160:163], v[72:75], a[164:167]
    ds_read_b128 a[136:139], v1 offset:58368
    ds_read_b128 a[140:143], v2 offset:58368
    v_mfma_f32_16x16x32_bf16 v[48:51], a[100:103], a[4:7], v[48:51]
    v_fma_f32 v64, v64, s29, v9
    v_fma_f32 v65, v65, s29, v9
    v_mfma_f32_16x16x32_bf16 v[52:55], a[124:127], a[60:63], 0
    ds_read_b128 a[144:147], v1 offset:59392
    v_fma_f32 v66, v66, s29, v9
    v_mfma_f32_16x16x32_bf16 v[52:55], a[120:123], a[56:59], v[52:55]
    v_fma_f32 v67, v67, s29, v9
    v_fma_f32 v68, v68, s29, v10
    v_mfma_f32_16x16x32_bf16 v[52:55], a[116:119], a[52:55], v[52:55]
    ds_read_b128 a[148:151], v2 offset:59392
    v_fma_f32 v69, v69, s29, v10
    v_mfma_f32_16x16x32_bf16 v[52:55], a[112:115], a[48:51], v[52:55]
    v_exp_f32 v64, v64
    v_mfma_f32_16x16x32_bf16 v[52:55], a[108:111], a[44:47], v[52:55]
    v_exp_f32 v65, v65
    v_mfma_f32_16x16x32_bf16 v[52:55], a[104:107], a[40:43], v[52:55]
    s_waitcnt vmcnt(0)
    ds_read_b128 a[152:155], v1 offset:60416
    v_cvt_pk_bf16_f32 v78, v64, v65
    v_mfma_f32_16x16x32_bf16 v[52:55], a[100:103], a[36:39], v[52:55]
    s_barrier
    v_exp_f32 v66, v66
    v_mfma_f32_16x16x32_bf16 v[52:55], a[96:99], a[32:35], v[52:55]
    v_exp_f32 v67, v67
    v_mfma_f32_16x16x32_bf16 v[56:59], a[96:99], a[64:67], 0
    ds_read_b64_tr_b16 a[96:97], v3 offset:32768
    ds_read_b64_tr_b16 a[98:99], v3 offset:40960
    v_mfma_f32_16x16x32_bf16 v[48:51], a[104:107], a[8:11], v[48:51]
    ds_read_b128 a[156:159], v2 offset:60416
    v_cvt_pk_bf16_f32 v79, v66, v67
    v_mfma_f32_16x16x32_bf16 v[48:51], a[108:111], a[12:15], v[48:51]
    v_fma_f32 v70, v70, s29, v10
    v_fma_f32 v71, v71, s29, v10
    v_mfma_f32_16x16x32_bf16 v[56:59], a[100:103], a[68:71], v[56:59]
    ds_read_b64_tr_b16 a[100:101], v3 offset:49152
    ds_read_b64_tr_b16 a[102:103], v3 offset:57344
    v_mfma_f32_16x16x32_bf16 v[48:51], a[112:115], a[16:19], v[48:51]
    v_exp_f32 v68, v68
    v_mfma_f32_16x16x32_bf16 v[48:51], a[116:119], a[20:23], v[48:51]
    v_exp_f32 v69, v69
    v_mfma_f32_16x16x32_bf16 v[56:59], a[104:107], a[72:75], v[56:59]
    ds_read_b64_tr_b16 a[104:105], v3 offset:0
    ds_read_b64_tr_b16 a[106:107], v3 offset:8192
    v_mfma_f32_16x16x32_bf16 a[168:171], a[160:163], v[76:79], a[168:171]
    v_exp_f32 v70, v70
    v_mfma_f32_16x16x32_bf16 v[48:51], a[120:123], a[24:27], v[48:51]
    v_exp_f32 v71, v71
    v_mfma_f32_16x16x32_bf16 v[56:59], a[108:111], a[76:79], v[56:59]
    ds_read_b64_tr_b16 a[108:109], v3 offset:16384
    ds_read_b64_tr_b16 a[110:111], v3 offset:24576
    v_mfma_f32_16x16x32_bf16 v[48:51], a[124:127], a[28:31], v[48:51]
    v_cvt_pk_bf16_f32 v82, v68, v69
    v_cvt_pk_bf16_f32 v83, v70, v71
    v_mfma_f32_16x16x32_bf16 v[56:59], a[112:115], a[80:83], v[56:59]
    ds_read_b64_tr_b16 a[112:113], v40 offset:0
    ds_read_b64_tr_b16 a[114:115], v40 offset:8192
    v_mfma_f32_16x16x32_bf16 v[56:59], a[116:119], a[84:87], v[56:59]
    ds_read_b64_tr_b16 a[116:117], v40 offset:16384
    ds_read_b64_tr_b16 a[118:119], v40 offset:24576
    v_mfma_f32_16x16x32_bf16 v[56:59], a[120:123], a[88:91], v[56:59]
    ds_read_b64_tr_b16 a[120:121], v4 offset:32768
    ds_read_b64_tr_b16 a[122:123], v4 offset:40960
    v_mfma_f32_16x16x32_bf16 v[56:59], a[124:127], a[92:95], v[56:59]
    ds_read_b64_tr_b16 a[124:125], v4 offset:49152
    ds_read_b64_tr_b16 a[126:127], v4 offset:57344
    v_mfma_f32_16x16x32_bf16 a[172:175], a[160:163], v[80:83], a[172:175]
    s_waitcnt lgkmcnt(10)
    v_fma_f32 v48, v48, s29, v8
    v_fma_f32 v49, v49, s29, v8
    v_mfma_f32_16x16x32_bf16 v[60:63], a[128:131], a[0:3], 0
    ds_read_b64_tr_b16 a[0:1], v4 offset:0
    ds_read_b64_tr_b16 a[2:3], v4 offset:8192
    v_mfma_f32_16x16x32_bf16 v[60:63], a[132:135], a[4:7], v[60:63]
    ds_read_b64_tr_b16 a[4:5], v4 offset:16384
    ds_read_b64_tr_b16 a[6:7], v4 offset:24576
    v_mfma_f32_16x16x32_bf16 v[60:63], a[136:139], a[8:11], v[60:63]
    ds_read_b64_tr_b16 a[8:9], v41 offset:0
    ds_read_b64_tr_b16 a[10:11], v41 offset:8192
    v_mfma_f32_16x16x32_bf16 v[60:63], a[140:143], a[12:15], v[60:63]
    ds_read_b64_tr_b16 a[12:13], v41 offset:16384
    ds_read_b64_tr_b16 a[14:15], v41 offset:24576
    v_mfma_f32_16x16x32_bf16 v[60:63], a[144:147], a[16:19], v[60:63]
    ds_read_b64_tr_b16 a[16:17], v5 offset:32768
    ds_read_b64_tr_b16 a[18:19], v5 offset:40960
    v_fma_f32 v50, v50, s29, v8
    v_fma_f32 v51, v51, s29, v8
    v_exp_f32 v48, v48
    v_exp_f32 v49, v49
    v_mfma_f32_16x16x32_bf16 v[60:63], a[148:151], a[20:23], v[60:63]
    ds_read_b64_tr_b16 a[20:21], v5 offset:49152
    ds_read_b64_tr_b16 a[22:23], v5 offset:57344
    v_exp_f32 v50, v50
    v_exp_f32 v51, v51
    v_cvt_pk_bf16_f32 v84, v48, v49
    v_mfma_f32_16x16x32_bf16 v[60:63], a[152:155], a[24:27], v[60:63]
    ds_read_b64_tr_b16 a[24:25], v5 offset:0
    ds_read_b64_tr_b16 a[26:27], v5 offset:8192
    v_cvt_pk_bf16_f32 v85, v50, v51
    v_mfma_f32_16x16x32_bf16 v[60:63], a[156:159], a[28:31], v[60:63]
    ds_read_b64_tr_b16 a[28:29], v5 offset:16384
    ds_read_b64_tr_b16 a[30:31], v5 offset:24576
    v_mfma_f32_16x16x32_bf16 v[64:67], a[156:159], a[60:63], 0
    v_fma_f32 v52, v52, s29, v9
    v_fma_f32 v53, v53, s29, v9
    v_mfma_f32_16x16x32_bf16 v[64:67], a[152:155], a[56:59], v[64:67]
    v_fma_f32 v54, v54, s29, v9
    v_fma_f32 v55, v55, s29, v9
    v_mfma_f32_16x16x32_bf16 v[64:67], a[148:151], a[52:55], v[64:67]
    ds_read_b64_tr_b16 a[52:53], v6 offset:16384
    ds_read_b64_tr_b16 a[54:55], v6 offset:24576
    v_mfma_f32_16x16x32_bf16 v[64:67], a[144:147], a[48:51], v[64:67]
    ds_read_b64_tr_b16 a[48:49], v6 offset:0
    ds_read_b64_tr_b16 a[50:51], v6 offset:8192
    v_mfma_f32_16x16x32_bf16 v[64:67], a[140:143], a[44:47], v[64:67]
    ds_read_b64_tr_b16 a[44:45], v6 offset:49152
    ds_read_b64_tr_b16 a[46:47], v6 offset:57344
    v_mfma_f32_16x16x32_bf16 v[64:67], a[136:139], a[40:43], v[64:67]
    ds_read_b64_tr_b16 a[40:41], v6 offset:32768
    ds_read_b64_tr_b16 a[42:43], v6 offset:40960
    v_mfma_f32_16x16x32_bf16 v[64:67], a[132:135], a[36:39], v[64:67]
    ds_read_b64_tr_b16 a[36:37], v42 offset:16384
    ds_read_b64_tr_b16 a[38:39], v42 offset:24576
    v_mfma_f32_16x16x32_bf16 v[64:67], a[128:131], a[32:35], v[64:67]
    ds_read_b64_tr_b16 a[32:33], v42 offset:0
    ds_read_b64_tr_b16 a[34:35], v42 offset:8192
    v_mfma_f32_16x16x32_bf16 v[68:71], a[128:131], a[64:67], 0
    ds_read_b64_tr_b16 a[56:57], v43 offset:0
    ds_read_b64_tr_b16 a[58:59], v43 offset:8192
    v_exp_f32 v52, v52
    v_exp_f32 v53, v53
    v_exp_f32 v54, v54
    v_exp_f32 v55, v55
    v_cvt_pk_bf16_f32 v88, v52, v53
    v_cvt_pk_bf16_f32 v89, v54, v55
    v_fma_f32 v56, v56, s29, v10
    v_fma_f32 v57, v57, s29, v10
    v_fma_f32 v58, v58, s29, v10
    v_fma_f32 v59, v59, s29, v10
    v_exp_f32 v56, v56
    v_exp_f32 v57, v57
    v_exp_f32 v58, v58
    v_exp_f32 v59, v59
    v_cvt_pk_bf16_f32 v92, v56, v57
    v_cvt_pk_bf16_f32 v93, v58, v59
    v_mfma_f32_16x16x32_bf16 v[68:71], a[132:135], a[68:71], v[68:71]
    ds_read_b64_tr_b16 a[60:61], v43 offset:16384
    ds_read_b64_tr_b16 a[62:63], v43 offset:24576
    v_mfma_f32_16x16x32_bf16 v[68:71], a[136:139], a[72:75], v[68:71]
    v_fma_f32 v60, v60, s29, v8
    v_fma_f32 v61, v61, s29, v8
    v_mfma_f32_16x16x32_bf16 v[68:71], a[140:143], a[76:79], v[68:71]
    v_fma_f32 v62, v62, s29, v8
    v_fma_f32 v63, v63, s29, v8
    v_mfma_f32_16x16x32_bf16 v[68:71], a[144:147], a[80:83], v[68:71]
    v_exp_f32 v60, v60
    v_mfma_f32_16x16x32_bf16 v[68:71], a[148:151], a[84:87], v[68:71]
    v_exp_f32 v61, v61
    v_mfma_f32_16x16x32_bf16 v[68:71], a[152:155], a[88:91], v[68:71]
    v_exp_f32 v62, v62
    v_mfma_f32_16x16x32_bf16 v[68:71], a[156:159], a[92:95], v[68:71]
    v_exp_f32 v63, v63
    v_mfma_f32_16x16x32_bf16 v[96:99], a[96:99], a[224:227], v[96:99]
    v_cvt_pk_bf16_f32 v86, v60, v61
    v_cvt_pk_bf16_f32 v87, v62, v63
    v_mfma_f32_16x16x32_bf16 v[96:99], a[100:103], a[236:239], v[96:99]
    v_fma_f32 v64, v64, s29, v9
    v_fma_f32 v65, v65, s29, v9
    v_mfma_f32_16x16x32_bf16 a[164:167], a[160:163], v[84:87], a[164:167]
    v_fma_f32 v66, v66, s29, v9
    v_fma_f32 v67, v67, s29, v9
    v_mfma_f32_16x16x32_bf16 v[96:99], a[104:107], a[248:251], v[96:99]
    s_waitcnt lgkmcnt(0)
    v_exp_f32 v64, v64
    v_mfma_f32_16x16x32_bf16 v[96:99], a[108:111], a[184:187], v[96:99]
    v_exp_f32 v65, v65
    v_mfma_f32_16x16x32_bf16 v[96:99], a[112:115], v[72:75], v[96:99]
    v_exp_f32 v66, v66
    v_mfma_f32_16x16x32_bf16 v[96:99], a[116:119], v[84:87], v[96:99]
    v_exp_f32 v67, v67
    v_mfma_f32_16x16x32_bf16 v[108:111], a[12:15], v[84:87], v[108:111]
    v_cvt_pk_bf16_f32 v90, v64, v65
    v_cvt_pk_bf16_f32 v91, v66, v67
    v_mfma_f32_16x16x32_bf16 v[108:111], a[8:11], v[72:75], v[108:111]
    v_accvgpr_read_b32 v36, a164
    v_add_f32 v14, v14, v36
    v_mfma_f32_16x16x32_bf16 a[168:171], a[160:163], v[88:91], a[168:171]
    v_rcp_f32 v26, v14
    v_mfma_f32_16x16x32_bf16 v[108:111], a[4:7], a[184:187], v[108:111]
    v_fma_f32 v68, v68, s29, v10
    v_fma_f32 v69, v69, s29, v10
    v_mfma_f32_16x16x32_bf16 v[108:111], a[0:3], a[248:251], v[108:111]
    v_fma_f32 v70, v70, s29, v10
    v_fma_f32 v71, v71, s29, v10
    v_mfma_f32_16x16x32_bf16 v[108:111], a[124:127], a[236:239], v[108:111]
    v_exp_f32 v68, v68
    v_mfma_f32_16x16x32_bf16 v[108:111], a[120:123], a[224:227], v[108:111]
    v_exp_f32 v69, v69
    v_mfma_f32_16x16x32_bf16 v[120:123], a[16:19], a[224:227], v[120:123]
    v_exp_f32 v70, v70
    v_mfma_f32_16x16x32_bf16 v[120:123], a[20:23], a[236:239], v[120:123]
    v_exp_f32 v71, v71
    v_cvt_pk_bf16_f32 v94, v68, v69
    v_cvt_pk_bf16_f32 v95, v70, v71
    v_mfma_f32_16x16x32_bf16 v[120:123], a[24:27], a[248:251], v[120:123]
    v_accvgpr_read_b32 v37, a168
    v_add_f32 v15, v15, v37
    v_mfma_f32_16x16x32_bf16 a[172:175], a[160:163], v[92:95], a[172:175]
    v_rcp_f32 v27, v15
    v_mfma_f32_16x16x32_bf16 v[120:123], a[28:31], a[184:187], v[120:123]
    v_mul_f32 v96, v96, v26
    v_mul_f32 v97, v97, v26
    v_mfma_f32_16x16x32_bf16 v[120:123], a[32:35], v[72:75], v[120:123]
    v_mul_f32 v98, v98, v26
    v_mul_f32 v99, v99, v26
    v_mfma_f32_16x16x32_bf16 v[120:123], a[36:39], v[84:87], v[120:123]
    v_cvt_pk_bf16_f32 v96, v96, v97
    v_cvt_pk_bf16_f32 v97, v98, v99
    v_mfma_f32_16x16x32_bf16 v[132:135], a[60:63], v[84:87], v[132:135]
    ds_write_b64 v30, v[96:97] offset:0
    v_mfma_f32_16x16x32_bf16 v[132:135], a[56:59], v[72:75], v[132:135]
    v_accvgpr_read_b32 v38, a172
    v_add_f32 v16, v16, v38
    v_mfma_f32_16x16x32_bf16 v[132:135], a[52:55], a[184:187], v[132:135]
    v_rcp_f32 v28, v16
    v_mfma_f32_16x16x32_bf16 v[132:135], a[48:51], a[248:251], v[132:135]
    v_mul_f32 v108, v108, v26
    v_mul_f32 v109, v109, v26
    v_mfma_f32_16x16x32_bf16 v[132:135], a[44:47], a[236:239], v[132:135]
    v_mul_f32 v110, v110, v26
    v_mul_f32 v111, v111, v26
    v_mfma_f32_16x16x32_bf16 v[132:135], a[40:43], a[224:227], v[132:135]
    v_cvt_pk_bf16_f32 v108, v108, v109
    v_cvt_pk_bf16_f32 v109, v110, v111
    v_mfma_f32_16x16x32_bf16 v[100:103], a[96:99], a[228:231], v[100:103]
    ds_write_b64 v31, v[108:109] offset:0
    v_mfma_f32_16x16x32_bf16 v[100:103], a[100:103], a[240:243], v[100:103]
    ds_read_b64_tr_b16 a[64:65], v3 offset:33792
    ds_read_b64_tr_b16 a[66:67], v3 offset:41984
    v_mfma_f32_16x16x32_bf16 v[100:103], a[104:107], a[252:255], v[100:103]
    v_mul_f32 v120, v120, v26
    v_mul_f32 v121, v121, v26
    v_mfma_f32_16x16x32_bf16 v[100:103], a[108:111], a[180:183], v[100:103]
    ds_read_b64_tr_b16 a[68:69], v3 offset:50176
    ds_read_b64_tr_b16 a[70:71], v3 offset:58368
    v_mfma_f32_16x16x32_bf16 v[100:103], a[112:115], v[76:79], v[100:103]
    v_mul_f32 v122, v122, v26
    v_mul_f32 v123, v123, v26
    v_mfma_f32_16x16x32_bf16 v[100:103], a[116:119], v[88:91], v[100:103]
    v_cvt_pk_bf16_f32 v120, v120, v121
    v_add_f32 v34, v14, v15
    v_add_f32 v34, v34, v16
    v_cmp_ngt_f32 vcc, s36, v34
    s_cmp_lg_u64 vcc, 0
    s_cselect_b32 s35, 1, 0
    v_mov_b32 v34, s35
    v_cvt_pk_bf16_f32 v121, v122, v123
    v_mul_f32 v132, v132, v26
    v_mul_f32 v133, v133, v26
    v_mul_f32 v134, v134, v26
    v_mul_f32 v135, v135, v26
    v_cvt_pk_bf16_f32 v132, v132, v133
    v_cvt_pk_bf16_f32 v133, v134, v135
    v_mfma_f32_16x16x32_bf16 v[112:115], a[12:15], v[88:91], v[112:115]
    ds_write_b64 v32, v[120:121] offset:0
    ds_write_b64 v33, v[132:133] offset:0
    ds_read_b128 v[96:99], v24 offset:0
    ds_read_b128 v[108:111], v24 offset:1024
    v_mfma_f32_16x16x32_bf16 v[112:115], a[8:11], v[76:79], v[112:115]
    ds_write_b32 v21, v34
    v_mfma_f32_16x16x32_bf16 v[112:115], a[4:7], a[180:183], v[112:115]
    ds_read_b64_tr_b16 a[72:73], v3 offset:1024
    ds_read_b64_tr_b16 a[74:75], v3 offset:9216
    v_mfma_f32_16x16x32_bf16 v[112:115], a[0:3], a[252:255], v[112:115]
    ds_read_b64_tr_b16 a[76:77], v3 offset:17408
    ds_read_b64_tr_b16 a[78:79], v3 offset:25600
    v_mfma_f32_16x16x32_bf16 v[112:115], a[124:127], a[240:243], v[112:115]
    ds_read_b64_tr_b16 a[80:81], v40 offset:1024
    ds_read_b64_tr_b16 a[82:83], v40 offset:9216
    v_mfma_f32_16x16x32_bf16 v[112:115], a[120:123], a[228:231], v[112:115]
    ds_read_b64_tr_b16 a[84:85], v40 offset:17408
    ds_read_b64_tr_b16 a[86:87], v40 offset:25600
    v_mfma_f32_16x16x32_bf16 v[124:127], a[16:19], a[228:231], v[124:127]
    ds_read_b64_tr_b16 a[88:89], v4 offset:33792
    ds_read_b64_tr_b16 a[90:91], v4 offset:41984
    v_mfma_f32_16x16x32_bf16 v[124:127], a[20:23], a[240:243], v[124:127]
    ds_read_b64_tr_b16 a[92:93], v4 offset:50176
    ds_read_b64_tr_b16 a[94:95], v4 offset:58368
    v_mfma_f32_16x16x32_bf16 v[124:127], a[24:27], a[252:255], v[124:127]
    ds_read_b64_tr_b16 a[128:129], v4 offset:1024
    ds_read_b64_tr_b16 a[130:131], v4 offset:9216
    v_mfma_f32_16x16x32_bf16 v[124:127], a[28:31], a[180:183], v[124:127]
    s_waitcnt lgkmcnt(12)
    buffer_store_dwordx4 v[96:99], v23, s[16:19], s96 offen sc1
    ds_read_b64_tr_b16 a[132:133], v4 offset:17408
    ds_read_b64_tr_b16 a[134:135], v4 offset:25600
    v_mul_f32 v100, v100, v27
    v_mul_f32 v101, v101, v27
    v_mfma_f32_16x16x32_bf16 v[124:127], a[32:35], v[76:79], v[124:127]
    ds_read_b64_tr_b16 a[136:137], v41 offset:1024
    ds_read_b64_tr_b16 a[138:139], v41 offset:9216
    v_mfma_f32_16x16x32_bf16 v[124:127], a[36:39], v[88:91], v[124:127]
    v_mul_f32 v102, v102, v27
    v_mul_f32 v103, v103, v27
    v_cvt_pk_bf16_f32 v100, v100, v101
    v_cvt_pk_bf16_f32 v101, v102, v103
    v_mfma_f32_16x16x32_bf16 v[136:139], a[60:63], v[88:91], v[136:139]
    ds_write_b64 v30, v[100:101] offset:2048
    v_mfma_f32_16x16x32_bf16 v[136:139], a[56:59], v[76:79], v[136:139]
    ds_read_b64_tr_b16 a[140:141], v41 offset:17408
    ds_read_b64_tr_b16 a[142:143], v41 offset:25600
    buffer_store_dwordx4 v[108:111], v23, s[16:19], s97 offen sc1
    ds_read_b64_tr_b16 a[144:145], v5 offset:33792
    ds_read_b64_tr_b16 a[146:147], v5 offset:41984
    ds_read_b64_tr_b16 a[148:149], v5 offset:50176
    ds_read_b64_tr_b16 a[150:151], v5 offset:58368
    v_mfma_f32_16x16x32_bf16 v[136:139], a[52:55], a[180:183], v[136:139]
    s_barrier
    ds_read_b32 v35, v22
    ds_read_b64_tr_b16 a[152:153], v5 offset:1024
    v_mfma_f32_16x16x32_bf16 v[136:139], a[48:51], a[252:255], v[136:139]
    ds_read_b64_tr_b16 a[154:155], v5 offset:9216
    v_mul_f32 v112, v112, v27
    v_mfma_f32_16x16x32_bf16 v[136:139], a[44:47], a[240:243], v[136:139]
    v_mul_f32 v113, v113, v27
    v_mul_f32 v114, v114, v27
    v_mfma_f32_16x16x32_bf16 v[136:139], a[40:43], a[228:231], v[136:139]
    v_mul_f32 v115, v115, v27
    v_cvt_pk_bf16_f32 v112, v112, v113
    v_cvt_pk_bf16_f32 v113, v114, v115
    v_mfma_f32_16x16x32_bf16 v[104:107], a[96:99], a[232:235], v[104:107]
    ds_write_b64 v31, v[112:113] offset:2048
    v_mfma_f32_16x16x32_bf16 v[104:107], a[100:103], a[244:247], v[104:107]
    ds_read_b64_tr_b16 a[156:157], v5 offset:17408
    ds_read_b64_tr_b16 a[158:159], v5 offset:25600
    v_mfma_f32_16x16x32_bf16 v[104:107], a[104:107], a[188:191], v[104:107]
    ds_read_b64_tr_b16 a[160:161], v42 offset:1024
    ds_read_b64_tr_b16 a[162:163], v42 offset:9216
    v_mfma_f32_16x16x32_bf16 v[104:107], a[108:111], a[176:179], v[104:107]
    ds_read_b64_tr_b16 a[164:165], v42 offset:17408
    ds_read_b64_tr_b16 a[166:167], v42 offset:25600
    v_mfma_f32_16x16x32_bf16 v[104:107], a[112:115], v[80:83], v[104:107]
    ds_read_b64_tr_b16 a[168:169], v6 offset:33792
    ds_read_b64_tr_b16 a[170:171], v6 offset:41984
    v_mfma_f32_16x16x32_bf16 v[104:107], a[116:119], v[92:95], v[104:107]
    v_mul_f32 v124, v124, v27
    v_mul_f32 v125, v125, v27
    v_mul_f32 v126, v126, v27
    v_mul_f32 v127, v127, v27
    v_cvt_pk_bf16_f32 v124, v124, v125
    v_cvt_pk_bf16_f32 v125, v126, v127
    v_mul_f32 v136, v136, v27
    v_mul_f32 v137, v137, v27
    v_mul_f32 v138, v138, v27
    v_mul_f32 v139, v139, v27
    v_cvt_pk_bf16_f32 v136, v136, v137
    v_cvt_pk_bf16_f32 v137, v138, v139
    v_mfma_f32_16x16x32_bf16 v[116:119], a[12:15], v[92:95], v[116:119]
    ds_write_b64 v32, v[124:125] offset:2048
    ds_write_b64 v33, v[136:137] offset:2048
    ds_read_b128 v[100:103], v24 offset:2048
    ds_read_b128 v[112:115], v24 offset:3072
    v_mfma_f32_16x16x32_bf16 v[116:119], a[8:11], v[80:83], v[116:119]
    ds_read_b64_tr_b16 a[172:173], v6 offset:50176
    ds_read_b64_tr_b16 a[174:175], v6 offset:58368
    v_mfma_f32_16x16x32_bf16 v[116:119], a[4:7], a[176:179], v[116:119]
    ds_read_b64_tr_b16 a[96:97], v6 offset:1024
    ds_read_b64_tr_b16 a[98:99], v6 offset:9216
    v_mfma_f32_16x16x32_bf16 v[116:119], a[0:3], a[188:191], v[116:119]
    ds_read_b64_tr_b16 a[100:101], v6 offset:17408
    ds_read_b64_tr_b16 a[102:103], v6 offset:25600
    v_mfma_f32_16x16x32_bf16 v[116:119], a[124:127], a[244:247], v[116:119]
    ds_read_b64_tr_b16 a[104:105], v43 offset:1024
    ds_read_b64_tr_b16 a[106:107], v43 offset:9216
    v_mfma_f32_16x16x32_bf16 v[116:119], a[120:123], a[232:235], v[116:119]
    ds_read_b64_tr_b16 a[108:109], v43 offset:17408
    ds_read_b64_tr_b16 a[110:111], v43 offset:25600
    v_mfma_f32_16x16x32_bf16 v[128:131], a[16:19], a[232:235], v[128:131]
    v_mul_f32 v104, v104, v28
    v_mul_f32 v105, v105, v28
    v_mfma_f32_16x16x32_bf16 v[128:131], a[20:23], a[244:247], v[128:131]
    s_waitcnt lgkmcnt(10)
    v_cmp_ne_u32 vcc, 0, v35
    s_cmp_lg_u64 vcc, 0
    v_mfma_f32_16x16x32_bf16 v[128:131], a[24:27], a[188:191], v[128:131]
    s_cselect_b32 s35, 1, 0
    s_andn2_b32 s35, s35, s44
    s_cbranch_scc1 L_redo
    v_mfma_f32_16x16x32_bf16 v[128:131], a[28:31], a[176:179], v[128:131]
    buffer_store_dwordx4 v[100:103], v23, s[16:19], s98 offen sc1
    v_mul_f32 v106, v106, v28
    v_mul_f32 v107, v107, v28
    v_cvt_pk_bf16_f32 v104, v104, v105
    v_cvt_pk_bf16_f32 v105, v106, v107
    v_mfma_f32_16x16x32_bf16 v[128:131], a[32:35], v[80:83], v[128:131]
    v_mul_f32 v116, v116, v28
    v_mfma_f32_16x16x32_bf16 v[128:131], a[36:39], v[92:95], v[128:131]
    v_mul_f32 v117, v117, v28
    v_mfma_f32_16x16x32_bf16 v[140:143], a[60:63], v[92:95], v[140:143]
    ds_write_b64 v30, v[104:105] offset:4096
    v_mfma_f32_16x16x32_bf16 v[140:143], a[56:59], v[80:83], v[140:143]
    v_mul_f32 v118, v118, v28
    v_mul_f32 v119, v119, v28
    v_mfma_f32_16x16x32_bf16 v[140:143], a[52:55], a[176:179], v[140:143]
    buffer_store_dwordx4 v[112:115], v23, s[16:19], s99 offen sc1
    v_cvt_pk_bf16_f32 v116, v116, v117
    v_cvt_pk_bf16_f32 v117, v118, v119
    ds_write_b64 v31, v[116:117] offset:4096
    v_mfma_f32_16x16x32_bf16 v[140:143], a[48:51], a[188:191], v[140:143]
    v_mul_f32 v128, v128, v28
    v_mul_f32 v129, v129, v28
    v_mfma_f32_16x16x32_bf16 v[140:143], a[44:47], a[244:247], v[140:143]
    v_mul_f32 v130, v130, v28
    v_mul_f32 v131, v131, v28
    v_mfma_f32_16x16x32_bf16 v[140:143], a[40:43], a[232:235], v[140:143]
    v_cvt_pk_bf16_f32 v128, v128, v129
    v_cvt_pk_bf16_f32 v129, v130, v131
    v_mfma_f32_16x16x32_bf16 v[144:147], a[64:67], a[224:227], v[144:147]
    ds_read_b64_tr_b16 a[112:113], v3 offset:34816
    ds_read_b64_tr_b16 a[114:115], v3 offset:43008
    v_mfma_f32_16x16x32_bf16 v[144:147], a[68:71], a[236:239], v[144:147]
    ds_read_b64_tr_b16 a[116:117], v3 offset:51200
    ds_read_b64_tr_b16 a[118:119], v3 offset:59392
    v_mfma_f32_16x16x32_bf16 v[144:147], a[72:75], a[248:251], v[144:147]
    v_mul_f32 v140, v140, v28
    v_mul_f32 v141, v141, v28
    v_mfma_f32_16x16x32_bf16 v[144:147], a[76:79], a[184:187], v[144:147]
    v_mul_f32 v142, v142, v28
    v_mul_f32 v143, v143, v28
    v_mfma_f32_16x16x32_bf16 v[144:147], a[80:83], v[72:75], v[144:147]
    v_cvt_pk_bf16_f32 v140, v140, v141
    v_cvt_pk_bf16_f32 v141, v142, v143
    v_mfma_f32_16x16x32_bf16 v[144:147], a[84:87], v[84:87], v[144:147]
    ds_write_b64 v32, v[128:129] offset:4096
    ds_write_b64 v33, v[140:141] offset:4096
    ds_read_b128 v[104:107], v24 offset:4096
    ds_read_b128 v[116:119], v24 offset:5120
    v_mfma_f32_16x16x32_bf16 v[156:159], a[140:143], v[84:87], v[156:159]
    ds_read_b64_tr_b16 a[120:121], v3 offset:2048
    ds_read_b64_tr_b16 a[122:123], v3 offset:10240
    v_mfma_f32_16x16x32_bf16 v[156:159], a[136:139], v[72:75], v[156:159]
    v_mul_f32 v144, v144, v26
    v_mul_f32 v145, v145, v26
    v_mfma_f32_16x16x32_bf16 v[156:159], a[132:135], a[184:187], v[156:159]
    v_mul_f32 v146, v146, v26
    v_mul_f32 v147, v147, v26
    v_mfma_f32_16x16x32_bf16 v[156:159], a[128:131], a[248:251], v[156:159]
    v_cvt_pk_bf16_f32 v144, v144, v145
    v_cvt_pk_bf16_f32 v145, v146, v147
    v_mfma_f32_16x16x32_bf16 v[156:159], a[92:95], a[236:239], v[156:159]
    ds_read_b64_tr_b16 a[124:125], v3 offset:18432
    ds_read_b64_tr_b16 a[126:127], v3 offset:26624
    v_mfma_f32_16x16x32_bf16 v[156:159], a[88:91], a[224:227], v[156:159]
    ds_read_b64_tr_b16 a[0:1], v40 offset:2048
    ds_read_b64_tr_b16 a[2:3], v40 offset:10240
    v_mfma_f32_16x16x32_bf16 v[168:171], a[144:147], a[224:227], v[168:171]
    ds_read_b64_tr_b16 a[4:5], v40 offset:18432
    ds_read_b64_tr_b16 a[6:7], v40 offset:26624
    v_mfma_f32_16x16x32_bf16 v[168:171], a[148:151], a[236:239], v[168:171]
    ds_read_b64_tr_b16 a[8:9], v4 offset:34816
    ds_read_b64_tr_b16 a[10:11], v4 offset:43008
    v_mfma_f32_16x16x32_bf16 v[168:171], a[152:155], a[248:251], v[168:171]
    s_waitcnt lgkmcnt(8)
    buffer_store_dwordx4 v[104:107], v23, s[16:19], s100 offen sc1
    ds_write_b64 v30, v[144:145] offset:0
    v_mul_f32 v156, v156, v26
    v_mfma_f32_16x16x32_bf16 v[168:171], a[156:159], a[184:187], v[168:171]
    v_mul_f32 v157, v157, v26
    v_mul_f32 v158, v158, v26
    v_mfma_f32_16x16x32_bf16 v[168:171], a[160:163], v[72:75], v[168:171]
    v_mul_f32 v159, v159, v26
    v_cvt_pk_bf16_f32 v156, v156, v157
    v_mfma_f32_16x16x32_bf16 v[168:171], a[164:167], v[84:87], v[168:171]
    v_cvt_pk_bf16_f32 v157, v158, v159
    v_mfma_f32_16x16x32_bf16 v[180:183], a[108:111], v[84:87], v[180:183]
    ds_read_b64_tr_b16 a[12:13], v4 offset:51200
    ds_read_b64_tr_b16 a[14:15], v4 offset:59392
    v_mfma_f32_16x16x32_bf16 v[180:183], a[104:107], v[72:75], v[180:183]
    ds_read_b64_tr_b16 a[16:17], v4 offset:2048
    buffer_store_dwordx4 v[116:119], v23, s[16:19], s101 offen sc1
    ds_write_b64 v31, v[156:157] offset:0
    v_mul_f32 v168, v168, v26
    v_mfma_f32_16x16x32_bf16 v[180:183], a[100:103], a[184:187], v[180:183]
    v_mul_f32 v169, v169, v26
    v_mul_f32 v170, v170, v26
    v_mfma_f32_16x16x32_bf16 v[180:183], a[96:99], a[248:251], v[180:183]
    v_mul_f32 v171, v171, v26
    v_cvt_pk_bf16_f32 v168, v168, v169
    v_mfma_f32_16x16x32_bf16 v[180:183], a[172:175], a[236:239], v[180:183]
    v_cvt_pk_bf16_f32 v169, v170, v171
    v_mfma_f32_16x16x32_bf16 v[180:183], a[168:171], a[224:227], v[180:183]
    ds_read_b64_tr_b16 a[18:19], v4 offset:10240
    ds_read_b64_tr_b16 a[20:21], v4 offset:18432
    v_mfma_f32_16x16x32_bf16 v[148:151], a[64:67], a[228:231], v[148:151]
    ds_read_b64_tr_b16 a[22:23], v4 offset:26624
    ds_read_b64_tr_b16 a[24:25], v41 offset:2048
    v_mfma_f32_16x16x32_bf16 v[148:151], a[68:71], a[240:243], v[148:151]
    ds_read_b64_tr_b16 a[26:27], v41 offset:10240
    ds_read_b64_tr_b16 a[28:29], v41 offset:18432
    v_mfma_f32_16x16x32_bf16 v[148:151], a[72:75], a[252:255], v[148:151]
    v_mul_f32 v180, v180, v26
    v_mul_f32 v181, v181, v26
    v_mfma_f32_16x16x32_bf16 v[148:151], a[76:79], a[180:183], v[148:151]
    v_mul_f32 v182, v182, v26
    v_mul_f32 v183, v183, v26
    v_mfma_f32_16x16x32_bf16 v[148:151], a[80:83], v[76:79], v[148:151]
    v_cvt_pk_bf16_f32 v180, v180, v181
    v_cvt_pk_bf16_f32 v181, v182, v183
    v_mfma_f32_16x16x32_bf16 v[148:151], a[84:87], v[88:91], v[148:151]
    ds_write_b64 v32, v[168:169] offset:0
    ds_write_b64 v33, v[180:181] offset:0
    ds_read_b128 v[144:147], v24 offset:0
    ds_read_b128 v[156:159], v24 offset:1024
    v_mfma_f32_16x16x32_bf16 v[160:163], a[140:143], v[88:91], v[160:163]
    ds_read_b64_tr_b16 a[30:31], v41 offset:26624
    ds_read_b64_tr_b16 a[32:33], v5 offset:34816
    v_mfma_f32_16x16x32_bf16 v[160:163], a[136:139], v[76:79], v[160:163]
    v_mul_f32 v148, v148, v27
    v_mul_f32 v149, v149, v27
    v_mfma_f32_16x16x32_bf16 v[160:163], a[132:135], a[180:183], v[160:163]
    v_mul_f32 v150, v150, v27
    v_mul_f32 v151, v151, v27
    v_mfma_f32_16x16x32_bf16 v[160:163], a[128:131], a[252:255], v[160:163]
    v_cvt_pk_bf16_f32 v148, v148, v149
    v_cvt_pk_bf16_f32 v149, v150, v151
    v_mfma_f32_16x16x32_bf16 v[160:163], a[92:95], a[240:243], v[160:163]
    ds_read_b64_tr_b16 a[34:35], v5 offset:43008
    ds_read_b64_tr_b16 a[36:37], v5 offset:51200
    v_mfma_f32_16x16x32_bf16 v[160:163], a[88:91], a[228:231], v[160:163]
    ds_read_b64_tr_b16 a[38:39], v5 offset:59392
    ds_read_b64_tr_b16 a[40:41], v5 offset:2048
    v_mfma_f32_16x16x32_bf16 v[172:175], a[144:147], a[228:231], v[172:175]
    ds_read_b64_tr_b16 a[42:43], v5 offset:10240
    ds_read_b64_tr_b16 a[44:45], v5 offset:18432
    v_mfma_f32_16x16x32_bf16 v[172:175], a[148:151], a[240:243], v[172:175]
    ds_read_b64_tr_b16 a[46:47], v5 offset:26624
    ds_read_b64_tr_b16 a[48:49], v42 offset:2048
    v_mfma_f32_16x16x32_bf16 v[172:175], a[152:155], a[252:255], v[172:175]
    s_waitcnt lgkmcnt(8)
    buffer_store_dwordx4 v[144:147], v23, s[16:19], s96 offen offset:128 sc1
    ds_write_b64 v30, v[148:149] offset:2048
    v_mul_f32 v160, v160, v27
    v_mfma_f32_16x16x32_bf16 v[172:175], a[156:159], a[180:183], v[172:175]
    v_mul_f32 v161, v161, v27
    v_mul_f32 v162, v162, v27
    v_mfma_f32_16x16x32_bf16 v[172:175], a[160:163], v[76:79], v[172:175]
    v_mul_f32 v163, v163, v27
    v_cvt_pk_bf16_f32 v160, v160, v161
    v_mfma_f32_16x16x32_bf16 v[172:175], a[164:167], v[88:91], v[172:175]
    v_cvt_pk_bf16_f32 v161, v162, v163
    v_mfma_f32_16x16x32_bf16 v[184:187], a[108:111], v[88:91], v[184:187]
    ds_read_b64_tr_b16 a[50:51], v42 offset:10240
    ds_read_b64_tr_b16 a[52:53], v42 offset:18432
    v_mfma_f32_16x16x32_bf16 v[184:187], a[104:107], v[76:79], v[184:187]
    ds_read_b64_tr_b16 a[54:55], v42 offset:26624
    buffer_store_dwordx4 v[156:159], v23, s[16:19], s97 offen offset:128 sc1
    ds_write_b64 v31, v[160:161] offset:2048
    ds_read_b64_tr_b16 a[56:57], v6 offset:34816
    v_mfma_f32_16x16x32_bf16 v[184:187], a[100:103], a[180:183], v[184:187]
    ds_read_b64_tr_b16 a[58:59], v6 offset:43008
    v_mul_f32 v172, v172, v27
    v_mfma_f32_16x16x32_bf16 v[184:187], a[96:99], a[252:255], v[184:187]
    ds_read_b64_tr_b16 a[60:61], v6 offset:51200
    ds_read_b64_tr_b16 a[62:63], v6 offset:59392
    v_mfma_f32_16x16x32_bf16 v[184:187], a[172:175], a[240:243], v[184:187]
    v_mul_f32 v173, v173, v27
    v_mul_f32 v174, v174, v27
    v_mfma_f32_16x16x32_bf16 v[184:187], a[168:171], a[228:231], v[184:187]
    v_mul_f32 v175, v175, v27
    v_cvt_pk_bf16_f32 v172, v172, v173
    v_mfma_f32_16x16x32_bf16 v[152:155], a[64:67], a[232:235], v[152:155]
    v_cvt_pk_bf16_f32 v173, v174, v175
    v_mfma_f32_16x16x32_bf16 v[152:155], a[68:71], a[244:247], v[152:155]
    ds_read_b64_tr_b16 a[64:65], v6 offset:2048
    ds_read_b64_tr_b16 a[66:67], v6 offset:10240
    v_mfma_f32_16x16x32_bf16 v[152:155], a[72:75], a[188:191], v[152:155]
    v_mul_f32 v184, v184, v27
    v_mul_f32 v185, v185, v27
    v_mfma_f32_16x16x32_bf16 v[152:155], a[76:79], a[176:179], v[152:155]
    v_mul_f32 v186, v186, v27
    v_mul_f32 v187, v187, v27
    v_mfma_f32_16x16x32_bf16 v[152:155], a[80:83], v[80:83], v[152:155]
    v_cvt_pk_bf16_f32 v184, v184, v185
    v_cvt_pk_bf16_f32 v185, v186, v187
    v_mfma_f32_16x16x32_bf16 v[152:155], a[84:87], v[92:95], v[152:155]
    ds_write_b64 v32, v[172:173] offset:2048
    ds_write_b64 v33, v[184:185] offset:2048
    ds_read_b128 v[148:151], v24 offset:2048
    ds_read_b128 v[160:163], v24 offset:3072
    v_mfma_f32_16x16x32_bf16 v[164:167], a[140:143], v[92:95], v[164:167]
    ds_read_b64_tr_b16 a[68:69], v6 offset:18432
    ds_read_b64_tr_b16 a[70:71], v6 offset:26624
    v_mfma_f32_16x16x32_bf16 v[164:167], a[136:139], v[80:83], v[164:167]
    ds_read_b64_tr_b16 a[72:73], v43 offset:2048
    ds_read_b64_tr_b16 a[74:75], v43 offset:10240
    v_mfma_f32_16x16x32_bf16 v[164:167], a[132:135], a[176:179], v[164:167]
    ds_read_b64_tr_b16 a[76:77], v43 offset:18432
    ds_read_b64_tr_b16 a[78:79], v43 offset:26624
    v_mfma_f32_16x16x32_bf16 v[164:167], a[128:131], a[188:191], v[164:167]
    v_mul_f32 v152, v152, v28
    v_mul_f32 v153, v153, v28
    v_mfma_f32_16x16x32_bf16 v[164:167], a[92:95], a[244:247], v[164:167]
    v_mul_f32 v154, v154, v28
    v_mul_f32 v155, v155, v28
    v_mfma_f32_16x16x32_bf16 v[164:167], a[88:91], a[232:235], v[164:167]
    v_cvt_pk_bf16_f32 v152, v152, v153
    v_cvt_pk_bf16_f32 v153, v154, v155
    v_mfma_f32_16x16x32_bf16 v[176:179], a[144:147], a[232:235], v[176:179]
    ds_read_b64_tr_b16 a[80:81], v3 offset:35840
    ds_read_b64_tr_b16 a[82:83], v3 offset:44032
    v_mfma_f32_16x16x32_bf16 v[176:179], a[148:151], a[244:247], v[176:179]
    ds_read_b64_tr_b16 a[84:85], v3 offset:52224
    ds_read_b64_tr_b16 a[86:87], v3 offset:60416
    v_mfma_f32_16x16x32_bf16 v[176:179], a[152:155], a[188:191], v[176:179]
    s_waitcnt lgkmcnt(6)
    buffer_store_dwordx4 v[148:151], v23, s[16:19], s98 offen offset:128 sc1
    ds_write_b64 v30, v[152:153] offset:4096
    v_mul_f32 v164, v164, v28
    v_mfma_f32_16x16x32_bf16 v[176:179], a[156:159], a[176:179], v[176:179]
    v_mul_f32 v165, v165, v28
    v_mul_f32 v166, v166, v28
    v_mfma_f32_16x16x32_bf16 v[176:179], a[160:163], v[80:83], v[176:179]
    v_mul_f32 v167, v167, v28
    v_cvt_pk_bf16_f32 v164, v164, v165
    v_mfma_f32_16x16x32_bf16 v[176:179], a[164:167], v[92:95], v[176:179]
    v_cvt_pk_bf16_f32 v165, v166, v167
    v_mfma_f32_16x16x32_bf16 v[188:191], a[108:111], v[92:95], v[188:191]
    ds_read_b64_tr_b16 a[88:89], v3 offset:3072
    ds_read_b64_tr_b16 a[90:91], v3 offset:11264
    v_mfma_f32_16x16x32_bf16 v[188:191], a[104:107], v[80:83], v[188:191]
    ds_read_b64_tr_b16 a[92:93], v3 offset:19456
    buffer_store_dwordx4 v[160:163], v23, s[16:19], s99 offen offset:128 sc1
    ds_write_b64 v31, v[164:165] offset:4096
    v_mul_f32 v176, v176, v28
    v_mfma_f32_16x16x32_bf16 v[188:191], a[100:103], a[176:179], v[188:191]
    v_mul_f32 v177, v177, v28
    v_mul_f32 v178, v178, v28
    v_mfma_f32_16x16x32_bf16 v[188:191], a[96:99], a[188:191], v[188:191]
    v_mul_f32 v179, v179, v28
    v_cvt_pk_bf16_f32 v176, v176, v177
    v_mfma_f32_16x16x32_bf16 v[188:191], a[172:175], a[244:247], v[188:191]
    v_cvt_pk_bf16_f32 v177, v178, v179
    v_mfma_f32_16x16x32_bf16 v[188:191], a[168:171], a[232:235], v[188:191]
    ds_read_b64_tr_b16 a[94:95], v3 offset:27648
    ds_read_b64_tr_b16 a[128:129], v40 offset:3072
    v_mfma_f32_16x16x32_bf16 v[192:195], a[112:115], a[224:227], v[192:195]
    ds_read_b64_tr_b16 a[130:131], v40 offset:11264
    ds_read_b64_tr_b16 a[132:133], v40 offset:19456
    v_mfma_f32_16x16x32_bf16 v[192:195], a[116:119], a[236:239], v[192:195]
    ds_read_b64_tr_b16 a[134:135], v40 offset:27648
    ds_read_b64_tr_b16 a[136:137], v4 offset:35840
    v_mfma_f32_16x16x32_bf16 v[192:195], a[120:123], a[248:251], v[192:195]
    v_mul_f32 v188, v188, v28
    v_mul_f32 v189, v189, v28
    v_mfma_f32_16x16x32_bf16 v[192:195], a[124:127], a[184:187], v[192:195]
    v_mul_f32 v190, v190, v28
    v_mul_f32 v191, v191, v28
    v_mfma_f32_16x16x32_bf16 v[192:195], a[0:3], v[72:75], v[192:195]
    v_cvt_pk_bf16_f32 v188, v188, v189
    v_cvt_pk_bf16_f32 v189, v190, v191
    v_mfma_f32_16x16x32_bf16 v[192:195], a[4:7], v[84:87], v[192:195]
    ds_write_b64 v32, v[176:177] offset:4096
    ds_write_b64 v33, v[188:189] offset:4096
    ds_read_b128 v[152:155], v24 offset:4096
    ds_read_b128 v[164:167], v24 offset:5120
    v_mfma_f32_16x16x32_bf16 v[204:207], a[28:31], v[84:87], v[204:207]
    ds_read_b64_tr_b16 a[138:139], v4 offset:44032
    ds_read_b64_tr_b16 a[140:141], v4 offset:52224
    v_mfma_f32_16x16x32_bf16 v[204:207], a[24:27], v[72:75], v[204:207]
    v_mul_f32 v192, v192, v26
    v_mul_f32 v193, v193, v26
    v_mfma_f32_16x16x32_bf16 v[204:207], a[20:23], a[184:187], v[204:207]
    v_mul_f32 v194, v194, v26
    v_mul_f32 v195, v195, v26
    v_mfma_f32_16x16x32_bf16 v[204:207], a[16:19], a[248:251], v[204:207]
    v_cvt_pk_bf16_f32 v192, v192, v193
    v_cvt_pk_bf16_f32 v193, v194, v195
    v_mfma_f32_16x16x32_bf16 v[204:207], a[12:15], a[236:239], v[204:207]
    ds_read_b64_tr_b16 a[142:143], v4 offset:60416
    ds_read_b64_tr_b16 a[144:145], v4 offset:3072
    v_mfma_f32_16x16x32_bf16 v[204:207], a[8:11], a[224:227], v[204:207]
    ds_read_b64_tr_b16 a[146:147], v4 offset:11264
    ds_read_b64_tr_b16 a[148:149], v4 offset:19456
    v_mfma_f32_16x16x32_bf16 v[216:219], a[32:35], a[224:227], v[216:219]
    ds_read_b64_tr_b16 a[150:151], v4 offset:27648
    ds_read_b64_tr_b16 a[152:153], v41 offset:3072
    v_mfma_f32_16x16x32_bf16 v[216:219], a[36:39], a[236:239], v[216:219]
    ds_read_b64_tr_b16 a[154:155], v41 offset:11264
    ds_read_b64_tr_b16 a[156:157], v41 offset:19456
    v_mfma_f32_16x16x32_bf16 v[216:219], a[40:43], a[248:251], v[216:219]
    s_waitcnt lgkmcnt(8)
    buffer_store_dwordx4 v[152:155], v23, s[16:19], s100 offen offset:128 sc1
    ds_write_b64 v30, v[192:193] offset:0
    v_mul_f32 v204, v204, v26
    v_mfma_f32_16x16x32_bf16 v[216:219], a[44:47], a[184:187], v[216:219]
    v_mul_f32 v205, v205, v26
    v_mul_f32 v206, v206, v26
    v_mfma_f32_16x16x32_bf16 v[216:219], a[48:51], v[72:75], v[216:219]
    v_mul_f32 v207, v207, v26
    v_cvt_pk_bf16_f32 v204, v204, v205
    v_mfma_f32_16x16x32_bf16 v[216:219], a[52:55], v[84:87], v[216:219]
    v_cvt_pk_bf16_f32 v205, v206, v207
    v_mfma_f32_16x16x32_bf16 v[228:231], a[76:79], v[84:87], v[228:231]
    ds_read_b64_tr_b16 a[158:159], v41 offset:27648
    ds_read_b64_tr_b16 a[160:161], v5 offset:35840
    v_mfma_f32_16x16x32_bf16 v[228:231], a[72:75], v[72:75], v[228:231]
    ds_read_b64_tr_b16 a[162:163], v5 offset:44032
    buffer_store_dwordx4 v[164:167], v23, s[16:19], s101 offen offset:128 sc1
    ds_write_b64 v31, v[204:205] offset:0
    v_mul_f32 v216, v216, v26
    v_mfma_f32_16x16x32_bf16 v[228:231], a[68:71], a[184:187], v[228:231]
    v_mul_f32 v217, v217, v26
    v_mul_f32 v218, v218, v26
    v_mfma_f32_16x16x32_bf16 v[228:231], a[64:67], a[248:251], v[228:231]
    v_mul_f32 v219, v219, v26
    v_cvt_pk_bf16_f32 v216, v216, v217
    v_mfma_f32_16x16x32_bf16 v[228:231], a[60:63], a[236:239], v[228:231]
    v_cvt_pk_bf16_f32 v217, v218, v219
    v_mfma_f32_16x16x32_bf16 v[228:231], a[56:59], a[224:227], v[228:231]
    ds_read_b64_tr_b16 a[164:165], v5 offset:52224
    ds_read_b64_tr_b16 a[166:167], v5 offset:60416
    v_mfma_f32_16x16x32_bf16 v[196:199], a[112:115], a[228:231], v[196:199]
    ds_read_b64_tr_b16 a[168:169], v5 offset:3072
    ds_read_b64_tr_b16 a[170:171], v5 offset:11264
    v_mfma_f32_16x16x32_bf16 v[196:199], a[116:119], a[240:243], v[196:199]
    ds_read_b64_tr_b16 a[172:173], v5 offset:19456
    ds_read_b64_tr_b16 a[174:175], v5 offset:27648
    v_mfma_f32_16x16x32_bf16 v[196:199], a[120:123], a[252:255], v[196:199]
    v_mul_f32 v228, v228, v26
    v_mul_f32 v229, v229, v26
    v_mfma_f32_16x16x32_bf16 v[196:199], a[124:127], a[180:183], v[196:199]
    v_mul_f32 v230, v230, v26
    v_mul_f32 v231, v231, v26
    v_mfma_f32_16x16x32_bf16 v[196:199], a[0:3], v[76:79], v[196:199]
    v_cvt_pk_bf16_f32 v228, v228, v229
    v_cvt_pk_bf16_f32 v229, v230, v231
    v_mfma_f32_16x16x32_bf16 v[196:199], a[4:7], v[88:91], v[196:199]
    ds_write_b64 v32, v[216:217] offset:0
    ds_write_b64 v33, v[228:229] offset:0
    ds_read_b128 v[192:195], v24 offset:0
    ds_read_b128 v[204:207], v24 offset:1024
    v_mfma_f32_16x16x32_bf16 v[208:211], a[28:31], v[88:91], v[208:211]
    ds_read_b64_tr_b16 a[96:97], v42 offset:3072
    ds_read_b64_tr_b16 a[98:99], v42 offset:11264
    v_mfma_f32_16x16x32_bf16 v[208:211], a[24:27], v[76:79], v[208:211]
    v_mul_f32 v196, v196, v27
    v_mul_f32 v197, v197, v27
    v_mfma_f32_16x16x32_bf16 v[208:211], a[20:23], a[180:183], v[208:211]
    v_mul_f32 v198, v198, v27
    v_mul_f32 v199, v199, v27
    v_mfma_f32_16x16x32_bf16 v[208:211], a[16:19], a[252:255], v[208:211]
    v_cvt_pk_bf16_f32 v196, v196, v197
    v_cvt_pk_bf16_f32 v197, v198, v199
    v_mfma_f32_16x16x32_bf16 v[208:211], a[12:15], a[240:243], v[208:211]
    ds_read_b64_tr_b16 a[100:101], v42 offset:19456
    ds_read_b64_tr_b16 a[102:103], v42 offset:27648
    v_mfma_f32_16x16x32_bf16 v[208:211], a[8:11], a[228:231], v[208:211]
    ds_read_b64_tr_b16 a[104:105], v6 offset:35840
    ds_read_b64_tr_b16 a[106:107], v6 offset:44032
    v_mfma_f32_16x16x32_bf16 v[220:223], a[32:35], a[228:231], v[220:223]
    ds_read_b64_tr_b16 a[108:109], v6 offset:52224
    ds_read_b64_tr_b16 a[110:111], v6 offset:60416
    v_mfma_f32_16x16x32_bf16 v[220:223], a[36:39], a[240:243], v[220:223]
    ds_write_b64 v30, v[196:197] offset:2048
    v_mfma_f32_16x16x32_bf16 v[220:223], a[40:43], a[252:255], v[220:223]
    s_waitcnt lgkmcnt(7)
    buffer_store_dwordx4 v[192:195], v23, s[16:19], s96 offen offset:256 sc1
    v_mul_f32 v208, v208, v27
    v_mul_f32 v209, v209, v27
    v_mul_f32 v210, v210, v27
    v_mul_f32 v211, v211, v27
    v_mfma_f32_16x16x32_bf16 v[220:223], a[44:47], a[180:183], v[220:223]
    v_cvt_pk_bf16_f32 v208, v208, v209
    v_cvt_pk_bf16_f32 v209, v210, v211
    v_mfma_f32_16x16x32_bf16 v[220:223], a[48:51], v[76:79], v[220:223]
    ds_write_b64 v31, v[208:209] offset:2048
    v_mfma_f32_16x16x32_bf16 v[220:223], a[52:55], v[88:91], v[220:223]
    v_mfma_f32_16x16x32_bf16 v[232:235], a[76:79], v[88:91], v[232:235]
    v_mfma_f32_16x16x32_bf16 v[232:235], a[72:75], v[76:79], v[232:235]
    buffer_store_dwordx4 v[204:207], v23, s[16:19], s97 offen offset:256 sc1
    v_mfma_f32_16x16x32_bf16 v[232:235], a[68:71], a[180:183], v[232:235]
    v_mfma_f32_16x16x32_bf16 v[232:235], a[64:67], a[252:255], v[232:235]
    v_mfma_f32_16x16x32_bf16 v[232:235], a[60:63], a[240:243], v[232:235]
    s_nop 1
    v_mul_f32 v220, v220, v27
    v_mfma_f32_16x16x32_bf16 v[232:235], a[56:59], a[228:231], v[232:235]
    v_mul_f32 v221, v221, v27
    v_mul_f32 v222, v222, v27
    v_mfma_f32_16x16x32_bf16 v[200:203], a[112:115], a[232:235], v[200:203]
    v_mul_f32 v223, v223, v27
    v_cvt_pk_bf16_f32 v220, v220, v221
    v_mfma_f32_16x16x32_bf16 v[200:203], a[116:119], a[244:247], v[200:203]
    v_cvt_pk_bf16_f32 v221, v222, v223
    v_mfma_f32_16x16x32_bf16 v[200:203], a[120:123], a[188:191], v[200:203]
    v_mul_f32 v232, v232, v27
    v_mul_f32 v233, v233, v27
    v_mfma_f32_16x16x32_bf16 v[200:203], a[124:127], a[176:179], v[200:203]
    v_mul_f32 v234, v234, v27
    v_mul_f32 v235, v235, v27
    v_mfma_f32_16x16x32_bf16 v[200:203], a[0:3], v[80:83], v[200:203]
    v_cvt_pk_bf16_f32 v232, v232, v233
    v_cvt_pk_bf16_f32 v233, v234, v235
    v_mfma_f32_16x16x32_bf16 v[200:203], a[4:7], v[92:95], v[200:203]
    ds_write_b64 v32, v[220:221] offset:2048
    ds_write_b64 v33, v[232:233] offset:2048
    ds_read_b128 v[196:199], v24 offset:2048
    ds_read_b128 v[208:211], v24 offset:3072
    v_mfma_f32_16x16x32_bf16 v[212:215], a[28:31], v[92:95], v[212:215]
    ds_read_b64_tr_b16 a[112:113], v6 offset:3072
    ds_read_b64_tr_b16 a[114:115], v6 offset:11264
    v_mfma_f32_16x16x32_bf16 v[212:215], a[24:27], v[80:83], v[212:215]
    ds_read_b64_tr_b16 a[116:117], v6 offset:19456
    ds_read_b64_tr_b16 a[118:119], v6 offset:27648
    v_mfma_f32_16x16x32_bf16 v[212:215], a[20:23], a[176:179], v[212:215]
    ds_read_b64_tr_b16 a[120:121], v43 offset:3072
    ds_read_b64_tr_b16 a[122:123], v43 offset:11264
    v_mfma_f32_16x16x32_bf16 v[212:215], a[16:19], a[188:191], v[212:215]
    ds_read_b64_tr_b16 a[124:125], v43 offset:19456
    ds_read_b64_tr_b16 a[126:127], v43 offset:27648
    v_mfma_f32_16x16x32_bf16 v[212:215], a[12:15], a[244:247], v[212:215]
    v_mul_f32 v200, v200, v28
    v_mul_f32 v201, v201, v28
    v_mfma_f32_16x16x32_bf16 v[212:215], a[8:11], a[232:235], v[212:215]
    v_mul_f32 v202, v202, v28
    v_mul_f32 v203, v203, v28
    v_mfma_f32_16x16x32_bf16 v[224:227], a[32:35], a[232:235], v[224:227]
    v_cvt_pk_bf16_f32 v200, v200, v201
    v_cvt_pk_bf16_f32 v201, v202, v203
    v_mfma_f32_16x16x32_bf16 v[224:227], a[36:39], a[244:247], v[224:227]
    ds_write_b64 v30, v[200:201] offset:4096
    v_mfma_f32_16x16x32_bf16 v[224:227], a[40:43], a[188:191], v[224:227]
    s_waitcnt lgkmcnt(6)
    buffer_store_dwordx4 v[196:199], v23, s[16:19], s98 offen offset:256 sc1
    v_mul_f32 v212, v212, v28
    v_mul_f32 v213, v213, v28
    v_mul_f32 v214, v214, v28
    v_mul_f32 v215, v215, v28
    v_mfma_f32_16x16x32_bf16 v[224:227], a[44:47], a[176:179], v[224:227]
    v_cvt_pk_bf16_f32 v212, v212, v213
    v_cvt_pk_bf16_f32 v213, v214, v215
    v_mfma_f32_16x16x32_bf16 v[224:227], a[48:51], v[80:83], v[224:227]
    ds_write_b64 v31, v[212:213] offset:4096
    v_mfma_f32_16x16x32_bf16 v[224:227], a[52:55], v[92:95], v[224:227]
    v_mfma_f32_16x16x32_bf16 v[236:239], a[76:79], v[92:95], v[236:239]
    v_mfma_f32_16x16x32_bf16 v[236:239], a[72:75], v[80:83], v[236:239]
    buffer_store_dwordx4 v[208:211], v23, s[16:19], s99 offen offset:256 sc1
    v_mfma_f32_16x16x32_bf16 v[236:239], a[68:71], a[176:179], v[236:239]
    v_mfma_f32_16x16x32_bf16 v[236:239], a[64:67], a[188:191], v[236:239]
    v_mfma_f32_16x16x32_bf16 v[236:239], a[60:63], a[244:247], v[236:239]
    s_nop 1
    v_mul_f32 v224, v224, v28
    v_mfma_f32_16x16x32_bf16 v[236:239], a[56:59], a[232:235], v[236:239]
    v_mul_f32 v225, v225, v28
    v_mul_f32 v226, v226, v28
    v_mfma_f32_16x16x32_bf16 v[240:243], a[80:83], a[224:227], v[240:243]
    v_mul_f32 v227, v227, v28
    v_cvt_pk_bf16_f32 v224, v224, v225
    v_mfma_f32_16x16x32_bf16 v[240:243], a[84:87], a[236:239], v[240:243]
    v_cvt_pk_bf16_f32 v225, v226, v227
    v_mfma_f32_16x16x32_bf16 v[240:243], a[88:91], a[248:251], v[240:243]
    v_mul_f32 v236, v236, v28
    v_mul_f32 v237, v237, v28
    v_mfma_f32_16x16x32_bf16 v[240:243], a[92:95], a[184:187], v[240:243]
    v_mul_f32 v238, v238, v28
    v_mul_f32 v239, v239, v28
    v_mfma_f32_16x16x32_bf16 v[240:243], a[128:131], v[72:75], v[240:243]
    v_cvt_pk_bf16_f32 v236, v236, v237
    v_cvt_pk_bf16_f32 v237, v238, v239
    v_mfma_f32_16x16x32_bf16 v[240:243], a[132:135], v[84:87], v[240:243]
    ds_write_b64 v32, v[224:225] offset:4096
    ds_write_b64 v33, v[236:237] offset:4096
    ds_read_b128 v[200:203], v24 offset:4096
    ds_read_b128 v[212:215], v24 offset:5120
    v_mfma_f32_16x16x32_bf16 v[252:255], a[156:159], v[84:87], v[252:255]
    v_mfma_f32_16x16x32_bf16 v[252:255], a[152:155], v[72:75], v[252:255]
    s_nop 1
    v_mul_f32 v240, v240, v26
    v_mfma_f32_16x16x32_bf16 v[252:255], a[148:151], a[184:187], v[252:255]
    v_mul_f32 v241, v241, v26
    v_mul_f32 v242, v242, v26
    v_mfma_f32_16x16x32_bf16 v[252:255], a[144:147], a[248:251], v[252:255]
    v_mul_f32 v243, v243, v26
    v_cvt_pk_bf16_f32 v240, v240, v241
    v_mfma_f32_16x16x32_bf16 v[252:255], a[140:143], a[236:239], v[252:255]
    v_cvt_pk_bf16_f32 v241, v242, v243
    v_mfma_f32_16x16x32_bf16 v[252:255], a[136:139], a[224:227], v[252:255]
    ds_write_b64 v30, v[240:241] offset:0
    v_mfma_f32_16x16x32_bf16 a[200:203], a[160:163], a[224:227], a[200:203]
    v_mfma_f32_16x16x32_bf16 a[200:203], a[164:167], a[236:239], a[200:203]
    v_mfma_f32_16x16x32_bf16 a[200:203], a[168:171], a[248:251], a[200:203]
    s_waitcnt lgkmcnt(2)
    buffer_store_dwordx4 v[200:203], v23, s[16:19], s100 offen offset:256 sc1
    s_nop 1
    v_mul_f32 v252, v252, v26
    v_mfma_f32_16x16x32_bf16 a[200:203], a[172:175], a[184:187], a[200:203]
    v_mul_f32 v253, v253, v26
    v_mul_f32 v254, v254, v26
    v_mfma_f32_16x16x32_bf16 a[200:203], a[96:99], v[72:75], a[200:203]
    v_mul_f32 v255, v255, v26
    v_cvt_pk_bf16_f32 v252, v252, v253
    v_mfma_f32_16x16x32_bf16 a[200:203], a[100:103], v[84:87], a[200:203]
    v_cvt_pk_bf16_f32 v253, v254, v255
    v_mfma_f32_16x16x32_bf16 a[212:215], a[124:127], v[84:87], a[212:215]
    ds_write_b64 v31, v[252:253] offset:0
    v_mfma_f32_16x16x32_bf16 a[212:215], a[120:123], v[72:75], a[212:215]
    s_waitcnt lgkmcnt(2)
    buffer_store_dwordx4 v[212:215], v23, s[16:19], s101 offen offset:256 sc1
    s_nop 1
    v_accvgpr_read_b32 v128, a200
    v_mfma_f32_16x16x32_bf16 a[212:215], a[116:119], a[184:187], a[212:215]
    v_mul_f32 v128, v128, v26
    v_accvgpr_read_b32 v129, a201
    v_mfma_f32_16x16x32_bf16 a[212:215], a[112:115], a[248:251], a[212:215]
    v_accvgpr_read_b32 v130, a202
    v_accvgpr_read_b32 v131, a203
    v_mfma_f32_16x16x32_bf16 a[212:215], a[108:111], a[236:239], a[212:215]
    v_mul_f32 v129, v129, v26
    v_mul_f32 v130, v130, v26
    v_mfma_f32_16x16x32_bf16 a[212:215], a[104:107], a[224:227], a[212:215]
    v_mul_f32 v131, v131, v26
    v_cvt_pk_bf16_f32 v128, v128, v129
    v_mfma_f32_16x16x32_bf16 v[244:247], a[80:83], a[228:231], v[244:247]
    v_cvt_pk_bf16_f32 v129, v130, v131
    v_mfma_f32_16x16x32_bf16 v[244:247], a[84:87], a[240:243], v[244:247]
    ds_write_b64 v32, v[128:129] offset:0
    v_mfma_f32_16x16x32_bf16 v[244:247], a[88:91], a[252:255], v[244:247]
    s_nop 0
    v_accvgpr_read_b32 v140, a212
    v_accvgpr_read_b32 v141, a213
    v_mfma_f32_16x16x32_bf16 v[244:247], a[92:95], a[180:183], v[244:247]
    v_accvgpr_read_b32 v142, a214
    v_accvgpr_read_b32 v143, a215
    v_mfma_f32_16x16x32_bf16 v[244:247], a[128:131], v[76:79], v[244:247]
    v_mul_f32 v140, v140, v26
    v_mul_f32 v141, v141, v26
    v_mfma_f32_16x16x32_bf16 v[244:247], a[132:135], v[88:91], v[244:247]
    v_mul_f32 v142, v142, v26
    v_mul_f32 v143, v143, v26
    v_cvt_pk_bf16_f32 v140, v140, v141
    v_cvt_pk_bf16_f32 v141, v142, v143
    v_mfma_f32_16x16x32_bf16 a[192:195], a[156:159], v[88:91], a[192:195]
    ds_write_b64 v33, v[140:141] offset:0
    ds_read_b128 v[240:243], v24 offset:0
    ds_read_b128 v[252:255], v24 offset:1024
    v_mfma_f32_16x16x32_bf16 a[192:195], a[152:155], v[76:79], a[192:195]
    v_mul_f32 v244, v244, v27
    v_mul_f32 v245, v245, v27
    v_mfma_f32_16x16x32_bf16 a[192:195], a[148:151], a[180:183], a[192:195]
    v_mul_f32 v246, v246, v27
    v_mul_f32 v247, v247, v27
    v_mfma_f32_16x16x32_bf16 a[192:195], a[144:147], a[252:255], a[192:195]
    v_cvt_pk_bf16_f32 v244, v244, v245
    v_cvt_pk_bf16_f32 v245, v246, v247
    v_mfma_f32_16x16x32_bf16 a[192:195], a[140:143], a[240:243], a[192:195]
    ds_write_b64 v30, v[244:245] offset:2048
    v_mfma_f32_16x16x32_bf16 a[192:195], a[136:139], a[228:231], a[192:195]
    v_mfma_f32_16x16x32_bf16 a[204:207], a[160:163], a[228:231], a[204:207]
    v_mfma_f32_16x16x32_bf16 a[204:207], a[164:167], a[240:243], a[204:207]
    s_waitcnt lgkmcnt(2)
    buffer_store_dwordx4 v[240:243], v23, s[16:19], s96 offen offset:384 sc1
    v_mfma_f32_16x16x32_bf16 a[204:207], a[168:171], a[252:255], a[204:207]
    v_mfma_f32_16x16x32_bf16 a[204:207], a[172:175], a[180:183], a[204:207]
    v_mfma_f32_16x16x32_bf16 a[204:207], a[96:99], v[76:79], a[204:207]
    s_nop 0
    v_accvgpr_read_b32 v120, a192
    v_mfma_f32_16x16x32_bf16 a[204:207], a[100:103], v[88:91], a[204:207]
    v_accvgpr_read_b32 v121, a193
    v_accvgpr_read_b32 v122, a194
    v_mfma_f32_16x16x32_bf16 a[216:219], a[124:127], v[88:91], a[216:219]
    v_accvgpr_read_b32 v123, a195
    v_mfma_f32_16x16x32_bf16 a[216:219], a[120:123], v[76:79], a[216:219]
    s_waitcnt lgkmcnt(1)
    buffer_store_dwordx4 v[252:255], v23, s[16:19], s97 offen offset:384 sc1
    v_mul_f32 v120, v120, v27
    v_mul_f32 v121, v121, v27
    v_mul_f32 v122, v122, v27
    v_mul_f32 v123, v123, v27
    v_mfma_f32_16x16x32_bf16 a[216:219], a[116:119], a[180:183], a[216:219]
    v_cvt_pk_bf16_f32 v120, v120, v121
    v_cvt_pk_bf16_f32 v121, v122, v123
    v_mfma_f32_16x16x32_bf16 a[216:219], a[112:115], a[252:255], a[216:219]
    v_accvgpr_read_b32 v132, a204
    v_mfma_f32_16x16x32_bf16 a[216:219], a[108:111], a[240:243], a[216:219]
    v_accvgpr_read_b32 v133, a205
    v_mfma_f32_16x16x32_bf16 a[216:219], a[104:107], a[228:231], a[216:219]
    v_accvgpr_read_b32 v134, a206
    v_mfma_f32_16x16x32_bf16 v[248:251], a[80:83], a[232:235], v[248:251]
    ds_write_b64 v31, v[120:121] offset:2048
    v_mfma_f32_16x16x32_bf16 v[248:251], a[84:87], a[244:247], v[248:251]
    v_accvgpr_read_b32 v135, a207
    v_mul_f32 v132, v132, v27
    v_mfma_f32_16x16x32_bf16 v[248:251], a[88:91], a[188:191], v[248:251]
    v_mul_f32 v133, v133, v27
    v_accvgpr_read_b32 v168, a216
    v_mfma_f32_16x16x32_bf16 v[248:251], a[92:95], a[176:179], v[248:251]
    v_accvgpr_read_b32 v169, a217
    v_accvgpr_read_b32 v170, a218
    v_mfma_f32_16x16x32_bf16 v[248:251], a[128:131], v[80:83], v[248:251]
    v_accvgpr_read_b32 v171, a219
    v_mul_f32 v168, v168, v27
    v_mfma_f32_16x16x32_bf16 v[248:251], a[132:135], v[92:95], v[248:251]
    v_mul_f32 v169, v169, v27
    v_mul_f32 v134, v134, v27
    v_mul_f32 v135, v135, v27
    v_cvt_pk_bf16_f32 v132, v132, v133
    v_mul_f32 v170, v170, v27
    v_mul_f32 v171, v171, v27
    v_cvt_pk_bf16_f32 v168, v168, v169
    v_cvt_pk_bf16_f32 v133, v134, v135
    v_cvt_pk_bf16_f32 v169, v170, v171
    v_mfma_f32_16x16x32_bf16 a[196:199], a[156:159], v[92:95], a[196:199]
    ds_write_b64 v32, v[132:133] offset:2048
    ds_write_b64 v33, v[168:169] offset:2048
    ds_read_b128 v[244:247], v24 offset:2048
    ds_read_b128 v[232:235], v24 offset:3072
    v_mfma_f32_16x16x32_bf16 a[196:199], a[152:155], v[80:83], a[196:199]
    v_mul_f32 v248, v248, v28
    v_mul_f32 v249, v249, v28
    v_mfma_f32_16x16x32_bf16 a[196:199], a[148:151], a[176:179], a[196:199]
    v_mul_f32 v250, v250, v28
    v_mul_f32 v251, v251, v28
    v_mfma_f32_16x16x32_bf16 a[196:199], a[144:147], a[188:191], a[196:199]
    v_cvt_pk_bf16_f32 v248, v248, v249
    v_cvt_pk_bf16_f32 v249, v250, v251
    v_mfma_f32_16x16x32_bf16 a[196:199], a[140:143], a[244:247], a[196:199]
    ds_write_b64 v30, v[248:249] offset:4096
    v_mfma_f32_16x16x32_bf16 a[196:199], a[136:139], a[232:235], a[196:199]
    v_mfma_f32_16x16x32_bf16 a[208:211], a[160:163], a[232:235], a[208:211]
    v_mfma_f32_16x16x32_bf16 a[208:211], a[164:167], a[244:247], a[208:211]
    v_mfma_f32_16x16x32_bf16 a[208:211], a[168:171], a[188:191], a[208:211]
    v_mfma_f32_16x16x32_bf16 a[208:211], a[172:175], a[176:179], a[208:211]
    s_waitcnt lgkmcnt(2)
    buffer_store_dwordx4 v[244:247], v23, s[16:19], s98 offen offset:384 sc1
    s_nop 1
    v_accvgpr_read_b32 v124, a196
    v_mfma_f32_16x16x32_bf16 a[208:211], a[96:99], v[80:83], a[208:211]
    v_mul_f32 v124, v124, v28
    v_accvgpr_read_b32 v125, a197
    v_mfma_f32_16x16x32_bf16 a[208:211], a[100:103], v[92:95], a[208:211]
    v_accvgpr_read_b32 v126, a198
    v_accvgpr_read_b32 v127, a199
    v_mfma_f32_16x16x32_bf16 a[220:223], a[124:127], v[92:95], a[220:223]
    v_mul_f32 v125, v125, v28
    v_mul_f32 v126, v126, v28
    v_mfma_f32_16x16x32_bf16 a[220:223], a[120:123], v[80:83], a[220:223]
    v_mul_f32 v127, v127, v28
    v_cvt_pk_bf16_f32 v124, v124, v125
    v_mfma_f32_16x16x32_bf16 a[220:223], a[116:119], a[176:179], a[220:223]
    s_waitcnt lgkmcnt(0)
    v_cvt_pk_bf16_f32 v125, v126, v127
    buffer_store_dwordx4 v[232:235], v23, s[16:19], s99 offen offset:384 sc1
    ds_write_b64 v31, v[124:125] offset:4096
    v_accvgpr_read_b32 v136, a208
    v_mfma_f32_16x16x32_bf16 a[220:223], a[112:115], a[188:191], a[220:223]
    v_accvgpr_read_b32 v137, a209
    v_accvgpr_read_b32 v138, a210
    v_mfma_f32_16x16x32_bf16 a[220:223], a[108:111], a[244:247], a[220:223]
    v_accvgpr_read_b32 v139, a211
    v_mul_f32 v136, v136, v28
    v_mfma_f32_16x16x32_bf16 a[220:223], a[104:107], a[232:235], a[220:223]
    v_mul_f32 v137, v137, v28
    v_mul_f32 v138, v138, v28
    v_mul_f32 v139, v139, v28
    v_cvt_pk_bf16_f32 v136, v136, v137
    v_cvt_pk_bf16_f32 v137, v138, v139
    ds_write_b64 v32, v[136:137] offset:4096
    s_nop 1
    v_accvgpr_read_b32 v172, a220
    v_mul_f32 v172, v172, v28
    v_accvgpr_read_b32 v173, a221
    v_accvgpr_read_b32 v174, a222
    v_accvgpr_read_b32 v175, a223
    v_mul_f32 v173, v173, v28
    v_mul_f32 v174, v174, v28
    v_mul_f32 v175, v175, v28
    v_cvt_pk_bf16_f32 v172, v172, v173
    v_cvt_pk_bf16_f32 v173, v174, v175
    ds_write_b64 v33, v[172:173] offset:4096
    ds_read_b128 v[248:251], v24 offset:4096
    ds_read_b128 v[236:239], v24 offset:5120
    s_waitcnt lgkmcnt(1)
    buffer_store_dwordx4 v[248:251], v23, s[16:19], s100 offen offset:384 sc1
    s_waitcnt lgkmcnt(0)
    buffer_store_dwordx4 v[236:239], v23, s[16:19], s101 offen offset:384 sc1
L_end:
    s_endpgm
L_redo:
    s_waitcnt vmcnt(0) lgkmcnt(0)
    s_barrier
    s_mov_b32 s25, s33
    s_mov_b32 s8, s50
    s_mov_b32 s9, s51
    s_mov_b32 s10, 262144
    s_mov_b32 s12, s52
    s_mov_b32 s13, s53
    s_mov_b32 s14, 262144
    s_add_u32 s45, s31, 0
    s_add_u32 m0, s38, 0
    s_nop 0
    buffer_load_dwordx4 v7, s[4:7], s45 offen nt lds
    s_add_u32 m0, s38, 896
    s_nop 0
    buffer_load_dwordx4 v7, s[4:7], s45 offen offset:128 nt lds
    s_add_u32 m0, s38, 1792
    s_nop 0
    buffer_load_dwordx4 v7, s[4:7], s45 offen offset:256 nt lds
    s_add_u32 m0, s38, 2688
    s_nop 0
    buffer_load_dwordx4 v7, s[4:7], s45 offen offset:384 nt lds
    s_add_u32 s46, s31, 4096
    s_add_u32 m0, s38, 4096
    s_nop 0
    buffer_load_dwordx4 v7, s[4:7], s46 offen nt lds
    s_add_u32 m0, s38, 4992
    s_nop 0
    buffer_load_dwordx4 v7, s[4:7], s46 offen offset:128 nt lds
    s_add_u32 m0, s38, 5888
    s_nop 0
    buffer_load_dwordx4 v7, s[4:7], s46 offen offset:256 nt lds
    s_add_u32 m0, s38, 6784
    s_nop 0
    buffer_load_dwordx4 v7, s[4:7], s46 offen offset:384 nt lds
    s_add_u32 s45, s31, 8192
    s_mov_b32 m0, s72
    s_nop 0
    buffer_load_dwordx4 v7, s[4:7], s45 offen nt lds
    s_mov_b32 m0, s73
    s_nop 0
    buffer_load_dwordx4 v7, s[4:7], s45 offen offset:128 nt lds
    s_mov_b32 m0, s74
    s_nop 0
    buffer_load_dwordx4 v7, s[4:7], s45 offen offset:256 nt lds
    s_mov_b32 m0, s75
    s_nop 0
    buffer_load_dwordx4 v7, s[4:7], s45 offen offset:384 nt lds
    s_add_u32 s46, s31, 12288
    s_mov_b32 m0, s84
    s_nop 0
    buffer_load_dwordx4 v7, s[4:7], s46 offen nt lds
    s_mov_b32 m0, s85
    s_nop 0
    buffer_load_dwordx4 v7, s[4:7], s46 offen offset:128 nt lds
    s_mov_b32 m0, s86
    s_nop 0
    buffer_load_dwordx4 v7, s[4:7], s46 offen offset:256 nt lds
    s_mov_b32 m0, s87
    s_nop 0
    buffer_load_dwordx4 v7, s[4:7], s46 offen offset:384 nt lds
    s_add_u32 s45, s31, 16384
    s_mov_b32 m0, s76
    s_nop 0
    buffer_load_dwordx4 v7, s[4:7], s45 offen nt lds
    s_mov_b32 m0, s77
    s_nop 0
    buffer_load_dwordx4 v7, s[4:7], s45 offen offset:128 nt lds
    s_mov_b32 m0, s78
    s_nop 0
    buffer_load_dwordx4 v7, s[4:7], s45 offen offset:256 nt lds
    s_mov_b32 m0, s79
    s_nop 0
    buffer_load_dwordx4 v7, s[4:7], s45 offen offset:384 nt lds
    s_add_u32 s46, s31, 20480
    s_mov_b32 m0, s88
    s_nop 0
    buffer_load_dwordx4 v7, s[4:7], s46 offen nt lds
    s_mov_b32 m0, s89
    s_nop 0
    buffer_load_dwordx4 v7, s[4:7], s46 offen offset:128 nt lds
    s_mov_b32 m0, s90
    s_nop 0
    buffer_load_dwordx4 v7, s[4:7], s46 offen offset:256 nt lds
    s_mov_b32 m0, s91
    s_nop 0
    buffer_load_dwordx4 v7, s[4:7], s46 offen offset:384 nt lds
    s_waitcnt vmcnt(0)
    ds_read_b128 a[0:3], v19 offset:0
    ds_read_b128 a[4:7], v20 offset:0
    ds_read_b128 a[8:11], v19 offset:1024
    ds_read_b128 a[12:15], v20 offset:1024
    ds_read_b128 a[16:19], v19 offset:2048
    ds_read_b128 a[20:23], v20 offset:2048
    ds_read_b128 a[24:27], v19 offset:3072
    ds_read_b128 a[28:31], v20 offset:3072
    ds_read_b128 a[32:35], v17 offset:32768
    ds_read_b128 a[36:39], v18 offset:32768
    ds_read_b128 a[40:43], v17 offset:33792
    ds_read_b128 a[44:47], v18 offset:33792
    ds_read_b128 a[48:51], v17 offset:34816
    ds_read_b128 a[52:55], v18 offset:34816
    ds_read_b128 a[56:59], v17 offset:35840
    ds_read_b128 a[60:63], v18 offset:35840
    ds_read_b128 a[64:67], v17 offset:49152
    ds_read_b128 a[68:71], v18 offset:49152
    ds_read_b128 a[72:75], v17 offset:50176
    ds_read_b128 a[76:79], v18 offset:50176
    ds_read_b128 a[80:83], v17 offset:51200
    ds_read_b128 a[84:87], v18 offset:51200
    ds_read_b128 a[88:91], v17 offset:52224
    ds_read_b128 a[92:95], v18 offset:52224
    v_mov_b32 v11, 0xff800000
    v_mov_b32 v12, 0xff800000
    v_mov_b32 v13, 0xff800000
    s_mov_b32 s27, 0
L_mx:
    s_mov_b32 m0, s64
    s_nop 0
    buffer_load_dwordx4 v7, s[8:11], s25 offen lds
    s_mov_b32 m0, s65
    s_nop 0
    buffer_load_dwordx4 v7, s[8:11], s25 offen offset:128 lds
    s_mov_b32 m0, s66
    s_nop 0
    buffer_load_dwordx4 v7, s[8:11], s25 offen offset:256 lds
    s_mov_b32 m0, s67
    s_nop 0
    buffer_load_dwordx4 v7, s[8:11], s25 offen offset:384 lds
    s_add_u32 s25, s25, 16384
    s_and_b32 s25, s25, 0x3ffff
    s_waitcnt vmcnt(0)
    s_barrier
    ds_read_b128 a[96:99], v1 offset:0
    ds_read_b128 a[100:103], v2 offset:0
    ds_read_b128 a[104:107], v1 offset:1024
    ds_read_b128 a[108:111], v2 offset:1024
    ds_read_b128 a[112:115], v1 offset:2048
    ds_read_b128 a[116:119], v2 offset:2048
    ds_read_b128 a[120:123], v1 offset:3072
    ds_read_b128 a[124:127], v2 offset:3072
    ds_read_b128 a[128:131], v1 offset:8192
    ds_read_b128 a[132:135], v2 offset:8192
    ds_read_b128 a[136:139], v1 offset:9216
    ds_read_b128 a[140:143], v2 offset:9216
    ds_read_b128 a[144:147], v1 offset:10240
    ds_read_b128 a[148:151], v2 offset:10240
    ds_read_b128 a[152:155], v1 offset:11264
    ds_read_b128 a[156:159], v2 offset:11264
    s_waitcnt lgkmcnt(0)
    s_barrier
    v_mfma_f32_16x16x32_bf16 v[48:51], a[96:99], a[0:3], 0
    v_mfma_f32_16x16x32_bf16 v[48:51], a[100:103], a[4:7], v[48:51]
    v_mfma_f32_16x16x32_bf16 v[48:51], a[104:107], a[8:11], v[48:51]
    v_mfma_f32_16x16x32_bf16 v[48:51], a[108:111], a[12:15], v[48:51]
    v_mfma_f32_16x16x32_bf16 v[48:51], a[112:115], a[16:19], v[48:51]
    v_mfma_f32_16x16x32_bf16 v[48:51], a[116:119], a[20:23], v[48:51]
    v_mfma_f32_16x16x32_bf16 v[48:51], a[120:123], a[24:27], v[48:51]
    v_mfma_f32_16x16x32_bf16 v[48:51], a[124:127], a[28:31], v[48:51]
    v_mfma_f32_16x16x32_bf16 v[60:63], a[156:159], a[28:31], 0
    v_mfma_f32_16x16x32_bf16 v[60:63], a[152:155], a[24:27], v[60:63]
    v_mfma_f32_16x16x32_bf16 v[60:63], a[148:151], a[20:23], v[60:63]
    v_mfma_f32_16x16x32_bf16 v[60:63], a[144:147], a[16:19], v[60:63]
    v_mfma_f32_16x16x32_bf16 v[60:63], a[140:143], a[12:15], v[60:63]
    v_mfma_f32_16x16x32_bf16 v[60:63], a[136:139], a[8:11], v[60:63]
    v_mfma_f32_16x16x32_bf16 v[60:63], a[132:135], a[4:7], v[60:63]
    v_mfma_f32_16x16x32_bf16 v[60:63], a[128:131], a[0:3], v[60:63]
    v_mfma_f32_16x16x32_bf16 v[52:55], a[96:99], a[32:35], 0
    v_mfma_f32_16x16x32_bf16 v[52:55], a[100:103], a[36:39], v[52:55]
    v_mfma_f32_16x16x32_bf16 v[52:55], a[104:107], a[40:43], v[52:55]
    v_mfma_f32_16x16x32_bf16 v[52:55], a[108:111], a[44:47], v[52:55]
    v_mfma_f32_16x16x32_bf16 v[52:55], a[112:115], a[48:51], v[52:55]
    v_mfma_f32_16x16x32_bf16 v[52:55], a[116:119], a[52:55], v[52:55]
    v_mfma_f32_16x16x32_bf16 v[52:55], a[120:123], a[56:59], v[52:55]
    v_mfma_f32_16x16x32_bf16 v[52:55], a[124:127], a[60:63], v[52:55]
    v_mfma_f32_16x16x32_bf16 v[64:67], a[156:159], a[60:63], 0
    v_mfma_f32_16x16x32_bf16 v[64:67], a[152:155], a[56:59], v[64:67]
    v_mfma_f32_16x16x32_bf16 v[64:67], a[148:151], a[52:55], v[64:67]
    v_mfma_f32_16x16x32_bf16 v[64:67], a[144:147], a[48:51], v[64:67]
    v_mfma_f32_16x16x32_bf16 v[64:67], a[140:143], a[44:47], v[64:67]
    v_mfma_f32_16x16x32_bf16 v[64:67], a[136:139], a[40:43], v[64:67]
    v_mfma_f32_16x16x32_bf16 v[64:67], a[132:135], a[36:39], v[64:67]
    v_mfma_f32_16x16x32_bf16 v[64:67], a[128:131], a[32:35], v[64:67]
    v_mfma_f32_16x16x32_bf16 v[56:59], a[96:99], a[64:67], 0
    v_mfma_f32_16x16x32_bf16 v[56:59], a[100:103], a[68:71], v[56:59]
    v_mfma_f32_16x16x32_bf16 v[56:59], a[104:107], a[72:75], v[56:59]
    v_mfma_f32_16x16x32_bf16 v[56:59], a[108:111], a[76:79], v[56:59]
    v_mfma_f32_16x16x32_bf16 v[56:59], a[112:115], a[80:83], v[56:59]
    v_mfma_f32_16x16x32_bf16 v[56:59], a[116:119], a[84:87], v[56:59]
    v_mfma_f32_16x16x32_bf16 v[56:59], a[120:123], a[88:91], v[56:59]
    v_mfma_f32_16x16x32_bf16 v[56:59], a[124:127], a[92:95], v[56:59]
    v_mfma_f32_16x16x32_bf16 v[68:71], a[156:159], a[92:95], 0
    v_mfma_f32_16x16x32_bf16 v[68:71], a[152:155], a[88:91], v[68:71]
    v_mfma_f32_16x16x32_bf16 v[68:71], a[148:151], a[84:87], v[68:71]
    v_mfma_f32_16x16x32_bf16 v[68:71], a[144:147], a[80:83], v[68:71]
    v_mfma_f32_16x16x32_bf16 v[68:71], a[140:143], a[76:79], v[68:71]
    v_mfma_f32_16x16x32_bf16 v[68:71], a[136:139], a[72:75], v[68:71]
    v_mfma_f32_16x16x32_bf16 v[68:71], a[132:135], a[68:71], v[68:71]
    v_mfma_f32_16x16x32_bf16 v[68:71], a[128:131], a[64:67], v[68:71]
    s_nop 15
    v_max3_f32 v11, v11, v48, v49
    v_max3_f32 v11, v11, v50, v51
    v_max3_f32 v11, v11, v60, v61
    v_max3_f32 v11, v11, v62, v63
    v_max3_f32 v12, v12, v52, v53
    v_max3_f32 v12, v12, v54, v55
    v_max3_f32 v12, v12, v64, v65
    v_max3_f32 v12, v12, v66, v67
    v_max3_f32 v13, v13, v56, v57
    v_max3_f32 v13, v13, v58, v59
    v_max3_f32 v13, v13, v68, v69
    v_max3_f32 v13, v13, v70, v71
    s_add_u32 s27, s27, 1
    s_cmp_lt_u32 s27, 16
    s_cbranch_scc1 L_mx
    v_mov_b32 v34, v11
    s_nop 1
    v_permlane32_swap_b32 v11, v34
    v_max_f32 v11, v11, v34
    v_mov_b32 v34, v11
    s_nop 1
    v_permlane16_swap_b32 v11, v34
    v_max_f32 v11, v11, v34
    v_mul_f32 v8, s30, v11
    v_mov_b32 v34, v12
    s_nop 1
    v_permlane32_swap_b32 v12, v34
    v_max_f32 v12, v12, v34
    v_mov_b32 v34, v12
    s_nop 1
    v_permlane16_swap_b32 v12, v34
    v_max_f32 v12, v12, v34
    v_mul_f32 v9, s30, v12
    v_mov_b32 v34, v13
    s_nop 1
    v_permlane32_swap_b32 v13, v34
    v_max_f32 v13, v13, v34
    v_mov_b32 v34, v13
    s_nop 1
    v_permlane16_swap_b32 v13, v34
    v_max_f32 v13, v13, v34
    v_mul_f32 v10, s30, v13
    s_mov_b32 s44, 1
    s_mov_b64 s[42:43], -1
    s_branch L_load
    s_endpgm
.section .rodata,"a"
.p2align 6
.amdhsa_kernel standalone__gqa_softmax__near_ridge_kernel
  .amdhsa_next_free_vgpr 512
  .amdhsa_next_free_sgpr 102
  .amdhsa_accum_offset 256
  .amdhsa_group_segment_fixed_size 0
  .amdhsa_kernarg_size 48
  .amdhsa_user_sgpr_count 2
  .amdhsa_user_sgpr_kernarg_segment_ptr 1
  .amdhsa_system_sgpr_workgroup_id_x 1
.end_amdhsa_kernel
```
